```python
import torch

def _softmax(x, axis=-1):
    return torch.softmax(x, dim=axis)
def _gelu(x):
    return torch.nn.functional.gelu(x, approximate="tanh")
def _silu(x):
    return torch.nn.functional.silu(x)
def _sigmoid(x):
    return torch.sigmoid(x)
def _layernorm(x, axis=-1, eps=1e-5):
    m = x.mean(dim=axis, keepdim=True)
    v = x.var(dim=axis, keepdim=True, unbiased=False)
    return (x - m) / torch.sqrt(v + eps)
def _scatter_add(tgt, idx, src, axis=0):
    return tgt.clone().index_add_(axis, idx, src)
def _segment_sum(src, seg, n):
    out = torch.zeros((n,) + src.shape[1:], dtype=src.dtype)
    return out.index_add_(0, seg, src)
def _pad(x, pw):
    flat = tuple(v for pair in reversed(pw) for v in pair)
    return torch.nn.functional.pad(x, flat)

kernel_name = 'standalone__batchnorm__prompt'

def setup_inputs():

    _w = (lambda a: (lambda t: t.to(torch.bfloat16) if t.is_floating_point() else t)(torch.as_tensor(a)))
    B, S, C = 4, 2048, 448
    K = 3
    return {
        "x": _w((lambda *s: torch.randn(*s, dtype=torch.bfloat16) * 0.05)(B, S, C)),
        "w": _w((lambda *s: torch.randn(*s, dtype=torch.bfloat16) * 0.05)(K, C, C) * (1.0 / (K * C) ** 0.5)),
        "mean": _w((lambda *s: torch.randn(*s, dtype=torch.bfloat16) * 0.05)(C) * 0.1),
        "var": _w(torch.abs((lambda *s: torch.randn(*s, dtype=torch.bfloat16) * 0.05)(C)) + 0.5),
        "g": _w((lambda *s: torch.randn(*s, dtype=torch.bfloat16) * 0.05)(C) + 1.0),
        "b": _w((lambda *s: torch.randn(*s, dtype=torch.bfloat16) * 0.05)(C) * 0.1),
    }

def reference(x, w, mean, var, g, b):
    K = 3
    P = K // 2
    S = x.shape[1]
    xp = _pad(x, ((0, 0), (P, P), (0, 0)))
    y = sum(torch.einsum('bsc,cd->bsd', xp[:, k:k + S, :], w[k]) for k in range(K))
    inv_std = 1.0 / torch.sqrt(var + 1e-5)
    y = (y - mean) * (g * inv_std) + b
    return _silu(y)
```

```asm
; @launch grid=(256,1,1) block=(512,1,1) lds=151808
.amdgcn_target "amdgcn-amd-amdhsa--gfx950"
.text
.globl standalone__batchnorm__prompt_kernel
.p2align 12
.fill 832, 4, 0xbf810000
.p2align 8
.type standalone__batchnorm__prompt_kernel,@function
standalone__batchnorm__prompt_kernel:
    s_load_dwordx4 s[4:7], s[0:1], 0
    v_lshrrev_b32 v1, 6, v0
    s_bfe_u32 s21, s2, 0x20001
    s_and_b32 s70, s2, 1
    v_readfirstlane_b32 s20, v1
    v_and_b32 v0, 63, v0
    s_lshl_b32 s71, s21, 11
    s_lshr_b32 s22, s2, 3
    s_cmp_ge_u32 s2, 224
    s_cbranch_scc0 L_main
    s_cmp_eq_u32 s20, 4
    s_cbranch_scc1 L_help0
    s_branch L_help
L_main:
    s_mul_i32 s23, s22, 37
    s_lshr_b32 s23, s23, 8
    s_mul_i32 s19, s23, 7
    s_sub_u32 s19, s22, s19
    s_lshl2_add_u32 s23, s70, s23
    s_cmp_eq_u32 s23, 0
    s_cselect_b32 s69, 1, 0
    s_mul_i32 s18, s23, 240
    s_add_u32 s18, s18, s71
    s_cmp_ge_u32 s20, 4
    s_cbranch_scc1 L_compute
    v_lshrrev_b32 v1, 3, v0
    v_and_b32 v2, 7, v0
    v_bfe_u32 v3, v0, 4, 1
    v_lshrrev_b32 v4, 5, v0
    v_lshlrev_b32 v4, 1, v4
    v_lshl_or_b32 v4, v3, 2, v4
    v_xor_b32 v4, v2, v4
    v_mul_u32_u24 v5, 896, v1
    v_mul_u32_u24 v6, 13440, v1
    v_lshl_add_u32 v6, v4, 4, v6
    s_and_b32 s36, s20, 1
    s_mul_i32 s44, s36, 107520
    s_add_u32 s44, s44, 896
    v_add_u32 v6, s44, v6
    s_lshr_b32 s44, s20, 1
    s_sub_u32 s44, 14, s44
    s_mul_i32 s64, s44, 896
    s_lshl_b32 s37, s20, 10
    s_movk_i32 s66, 1152
    s_sub_u32 s22, s18, 1
    s_mul_hi_i32 s67, s22, 896
    s_mul_i32 s22, s22, 896
    s_mov_b32 s26, 216832
    s_mov_b32 s27, 0x20000
    v_lshlrev_b32 v3, 1, v3
    v_xor_b32 v4, v2, v3
    v_lshl_add_u32 v7, v4, 4, v5
    s_lshl_b32 s38, s36, 6
    v_xor_b32 v7, s38, v7
    s_mul_i32 s44, s20, 7168
    v_add_u32 v20, s44, v7
    s_lshl_b32 s68, s19, 7
    s_sub_u32 s30, 1204224, s68
    s_mov_b32 s31, 0x20000
    s_lshl_b32 s44, s69, 31
    s_or_b32 s44, s44, 0x60
    s_cmp_eq_u32 s36, 0
    s_cselect_b32 s44, s44, 215936
    s_cselect_b32 s47, 0, 30848
    v_lshlrev_b32 v18, 4, v2
    v_xor_b32 v18, s44, v18
    s_lshl_b32 s38, s36, 10
    s_add_u32 s38, s38, 28800
    s_cmp_lt_u32 s20, 2
    s_cselect_b32 s38, s38, s47
    s_cselect_b64 s[72:73], -1, 0xff
    s_cselect_b64 vcc, -1, 0
    v_cndmask_b32 v18, v18, v6, vcc
    s_lshl_b32 s48, s19, 12
    s_add_u32 s48, s48, s37
    s_mul_i32 s56, s19, 1792
    s_sub_u32 s56, s64, s56
    s_movk_i32 s74, 0x1000
    s_movk_i32 s75, 1792
    s_add_u32 s65, s37, 28672
    s_add_u32 s46, s48, s74
    s_sub_u32 s45, s56, s75
    s_cmp_eq_u32 s46, s65
    s_cselect_b32 s49, s37, s46
    s_cselect_b32 s57, s64, s45
    s_add_u32 s46, s49, s74
    s_sub_u32 s45, s57, s75
    s_cmp_eq_u32 s46, s65
    s_cselect_b32 s50, s37, s46
    s_cselect_b32 s58, s64, s45
    s_add_u32 s46, s50, s74
    s_sub_u32 s45, s58, s75
    s_cmp_eq_u32 s46, s65
    s_cselect_b32 s51, s37, s46
    s_cselect_b32 s59, s64, s45
    s_add_u32 s46, s51, s74
    s_sub_u32 s45, s59, s75
    s_cmp_eq_u32 s46, s65
    s_cselect_b32 s52, s37, s46
    s_cselect_b32 s60, s64, s45
    s_add_u32 s46, s52, s74
    s_sub_u32 s45, s60, s75
    s_cmp_eq_u32 s46, s65
    s_cselect_b32 s53, s37, s46
    s_cselect_b32 s61, s64, s45
    s_add_u32 s46, s53, s74
    s_sub_u32 s45, s61, s75
    s_cmp_eq_u32 s46, s65
    s_cselect_b32 s54, s37, s46
    s_cselect_b32 s62, s64, s45
    s_waitcnt lgkmcnt(0)
    s_add_u32 s24, s4, s22
    s_addc_u32 s25, s5, s67
    s_add_u32 s28, s6, s68
    s_addc_u32 s29, s7, 0
    s_add_u32 m0, s48, s66
    s_nop 0
    buffer_load_dwordx4 v6, s[24:27], s56 offen lds
    s_add_u32 m0, s37, 93952
    s_mov_b32 s39, 0
    buffer_load_dwordx4 v20, s[28:31], s39 offen lds
    s_add_u32 m0, s37, 102144
    s_mov_b32 s39, 401408
    buffer_load_dwordx4 v20, s[28:31], s39 offen lds
    s_add_u32 m0, s37, 110336
    s_mov_b32 s39, 802816
    buffer_load_dwordx4 v20, s[28:31], s39 offen lds
    s_add_u32 m0, s38, 1024
    s_mov_b64 exec, s[72:73]
    buffer_load_dwordx4 v18, s[24:27], 0 offen lds
    s_mov_b64 exec, -1
    s_add_u32 m0, s49, s66
    s_nop 0
    buffer_load_dwordx4 v6, s[24:27], s57 offen lds
    s_add_u32 m0, s50, s66
    s_nop 0
    buffer_load_dwordx4 v6, s[24:27], s58 offen lds
    s_add_u32 m0, s51, s66
    s_nop 0
    buffer_load_dwordx4 v6, s[24:27], s59 offen lds
    s_add_u32 m0, s52, s66
    s_nop 0
    buffer_load_dwordx4 v6, s[24:27], s60 offen lds
    s_add_u32 m0, s53, s66
    s_nop 0
    buffer_load_dwordx4 v6, s[24:27], s61 offen lds
    s_add_u32 m0, s54, s66
    s_nop 0
    buffer_load_dwordx4 v6, s[24:27], s62 offen lds
    s_add_u32 m0, s37, 98048
    s_mov_b32 s39, 28672
    buffer_load_dwordx4 v20, s[28:31], s39 offen lds
    s_add_u32 m0, s37, 106240
    s_mov_b32 s39, 430080
    buffer_load_dwordx4 v20, s[28:31], s39 offen lds
    s_add_u32 m0, s37, 114432
    s_mov_b32 s39, 831488
    buffer_load_dwordx4 v20, s[28:31], s39 offen lds
    s_add_u32 m0, s38, 31872
    s_mov_b64 exec, s[72:73]
    buffer_load_dwordx4 v18, s[24:27], 0 offen offset:128 lds
    s_mov_b64 exec, -1
    s_add_u32 m0, s48, 32000
    s_nop 0
    buffer_load_dwordx4 v6, s[24:27], s56 offen offset:128 lds
    s_add_u32 m0, s49, 32000
    s_nop 0
    buffer_load_dwordx4 v6, s[24:27], s57 offen offset:128 lds
    s_add_u32 m0, s50, 32000
    s_nop 0
    buffer_load_dwordx4 v6, s[24:27], s58 offen offset:128 lds
    s_waitcnt vmcnt(7)
    s_barrier
    s_add_u32 m0, s51, 32000
    s_nop 0
    buffer_load_dwordx4 v6, s[24:27], s59 offen offset:128 lds
    s_add_u32 m0, s52, 32000
    s_nop 0
    buffer_load_dwordx4 v6, s[24:27], s60 offen offset:128 lds
    s_add_u32 m0, s53, 32000
    s_nop 0
    buffer_load_dwordx4 v6, s[24:27], s61 offen offset:128 lds
    s_add_u32 m0, s54, 32000
    s_nop 0
    buffer_load_dwordx4 v6, s[24:27], s62 offen offset:128 lds
    s_add_u32 m0, s37, 118528
    s_mov_b32 s39, 57344
    buffer_load_dwordx4 v20, s[28:31], s39 offen lds
    s_add_u32 m0, s37, 126720
    s_mov_b32 s39, 458752
    buffer_load_dwordx4 v20, s[28:31], s39 offen lds
    s_add_u32 m0, s37, 134912
    s_mov_b32 s39, 860160
    buffer_load_dwordx4 v20, s[28:31], s39 offen lds
    s_waitcnt vmcnt(11)
    s_barrier
    s_add_u32 m0, s37, 122624
    s_mov_b32 s39, 86016
    buffer_load_dwordx4 v20, s[28:31], s39 offen lds
    s_add_u32 m0, s37, 130816
    s_mov_b32 s39, 487424
    buffer_load_dwordx4 v20, s[28:31], s39 offen lds
    s_add_u32 m0, s37, 139008
    s_mov_b32 s39, 888832
    buffer_load_dwordx4 v20, s[28:31], s39 offen lds
    s_add_u32 m0, s38, 62720
    s_mov_b64 exec, s[72:73]
    buffer_load_dwordx4 v18, s[24:27], 0 offen offset:256 lds
    s_mov_b64 exec, -1
    s_add_u32 m0, s48, 62848
    s_nop 0
    buffer_load_dwordx4 v6, s[24:27], s56 offen offset:256 lds
    s_add_u32 m0, s49, 62848
    s_nop 0
    buffer_load_dwordx4 v6, s[24:27], s57 offen offset:256 lds
    s_add_u32 m0, s50, 62848
    s_nop 0
    buffer_load_dwordx4 v6, s[24:27], s58 offen offset:256 lds
    s_add_u32 m0, s37, 93952
    s_mov_b32 s39, 114688
    buffer_load_dwordx4 v20, s[28:31], s39 offen lds
    s_add_u32 m0, s37, 102144
    s_mov_b32 s39, 516096
    buffer_load_dwordx4 v20, s[28:31], s39 offen lds
    s_add_u32 m0, s37, 110336
    s_mov_b32 s39, 917504
    buffer_load_dwordx4 v20, s[28:31], s39 offen lds
    s_waitcnt vmcnt(10)
    s_barrier
    s_add_u32 m0, s51, 62848
    s_nop 0
    buffer_load_dwordx4 v6, s[24:27], s59 offen offset:256 lds
    s_add_u32 m0, s52, 62848
    s_nop 0
    buffer_load_dwordx4 v6, s[24:27], s60 offen offset:256 lds
    s_add_u32 m0, s53, 62848
    s_nop 0
    buffer_load_dwordx4 v6, s[24:27], s61 offen offset:256 lds
    s_add_u32 m0, s54, 62848
    s_nop 0
    buffer_load_dwordx4 v6, s[24:27], s62 offen offset:256 lds
    s_add_u32 m0, s37, 98048
    s_mov_b32 s39, 143360
    buffer_load_dwordx4 v20, s[28:31], s39 offen lds
    s_add_u32 m0, s37, 106240
    s_mov_b32 s39, 544768
    buffer_load_dwordx4 v20, s[28:31], s39 offen lds
    s_add_u32 m0, s37, 114432
    s_mov_b32 s39, 946176
    buffer_load_dwordx4 v20, s[28:31], s39 offen lds
    s_add_u32 m0, s48, 768
    s_nop 0
    buffer_load_dwordx4 v6, s[24:27], s56 offen offset:384 lds
    s_add_u32 m0, s38, 640
    s_mov_b64 exec, s[72:73]
    buffer_load_dwordx4 v18, s[24:27], 0 offen offset:384 lds
    s_mov_b64 exec, -1
    s_waitcnt vmcnt(16)
    s_barrier
    s_add_u32 m0, s37, 118528
    s_mov_b32 s39, 172032
    buffer_load_dwordx4 v20, s[28:31], s39 offen lds
    s_add_u32 m0, s37, 126720
    s_mov_b32 s39, 573440
    buffer_load_dwordx4 v20, s[28:31], s39 offen lds
    s_add_u32 m0, s37, 134912
    s_mov_b32 s39, 974848
    buffer_load_dwordx4 v20, s[28:31], s39 offen lds
    s_add_u32 m0, s49, 768
    s_nop 0
    buffer_load_dwordx4 v6, s[24:27], s57 offen offset:384 lds
    s_add_u32 m0, s50, 768
    s_nop 0
    buffer_load_dwordx4 v6, s[24:27], s58 offen offset:384 lds
    s_add_u32 m0, s51, 768
    s_nop 0
    buffer_load_dwordx4 v6, s[24:27], s59 offen offset:384 lds
    s_add_u32 m0, s52, 768
    s_nop 0
    buffer_load_dwordx4 v6, s[24:27], s60 offen offset:384 lds
    s_add_u32 m0, s53, 768
    s_nop 0
    buffer_load_dwordx4 v6, s[24:27], s61 offen offset:384 lds
    s_add_u32 m0, s54, 768
    s_nop 0
    buffer_load_dwordx4 v6, s[24:27], s62 offen offset:384 lds
    s_waitcnt vmcnt(14)
    s_barrier
    s_add_u32 m0, s37, 122624
    s_mov_b32 s39, 200704
    buffer_load_dwordx4 v20, s[28:31], s39 offen lds
    s_add_u32 m0, s37, 130816
    s_mov_b32 s39, 602112
    buffer_load_dwordx4 v20, s[28:31], s39 offen lds
    s_add_u32 m0, s37, 139008
    s_mov_b32 s39, 1003520
    buffer_load_dwordx4 v20, s[28:31], s39 offen lds
    s_add_u32 m0, s48, 31616
    s_nop 0
    buffer_load_dwordx4 v6, s[24:27], s56 offen offset:512 lds
    s_add_u32 m0, s38, 31488
    s_mov_b64 exec, s[72:73]
    buffer_load_dwordx4 v18, s[24:27], 0 offen offset:512 lds
    s_mov_b64 exec, -1
    s_waitcnt vmcnt(16)
    s_barrier
    s_add_u32 m0, s37, 93952
    s_mov_b32 s39, 229376
    buffer_load_dwordx4 v20, s[28:31], s39 offen lds
    s_add_u32 m0, s37, 102144
    s_mov_b32 s39, 630784
    buffer_load_dwordx4 v20, s[28:31], s39 offen lds
    s_add_u32 m0, s37, 110336
    s_mov_b32 s39, 1032192
    buffer_load_dwordx4 v20, s[28:31], s39 offen lds
    s_add_u32 m0, s49, 31616
    s_nop 0
    buffer_load_dwordx4 v6, s[24:27], s57 offen offset:512 lds
    s_add_u32 m0, s50, 31616
    s_nop 0
    buffer_load_dwordx4 v6, s[24:27], s58 offen offset:512 lds
    s_add_u32 m0, s51, 31616
    s_nop 0
    buffer_load_dwordx4 v6, s[24:27], s59 offen offset:512 lds
    s_add_u32 m0, s52, 31616
    s_nop 0
    buffer_load_dwordx4 v6, s[24:27], s60 offen offset:512 lds
    s_add_u32 m0, s53, 31616
    s_nop 0
    buffer_load_dwordx4 v6, s[24:27], s61 offen offset:512 lds
    s_add_u32 m0, s54, 31616
    s_nop 0
    buffer_load_dwordx4 v6, s[24:27], s62 offen offset:512 lds
    s_waitcnt vmcnt(14)
    s_barrier
    s_add_u32 m0, s37, 98048
    s_mov_b32 s39, 258048
    buffer_load_dwordx4 v20, s[28:31], s39 offen lds
    s_add_u32 m0, s37, 106240
    s_mov_b32 s39, 659456
    buffer_load_dwordx4 v20, s[28:31], s39 offen lds
    s_add_u32 m0, s37, 114432
    s_mov_b32 s39, 1060864
    buffer_load_dwordx4 v20, s[28:31], s39 offen lds
    s_add_u32 m0, s48, 62464
    s_nop 0
    buffer_load_dwordx4 v6, s[24:27], s56 offen offset:640 lds
    s_add_u32 m0, s38, 62336
    s_mov_b64 exec, s[72:73]
    buffer_load_dwordx4 v18, s[24:27], 0 offen offset:640 lds
    s_mov_b64 exec, -1
    s_load_dwordx8 s[8:15], s[0:1], 16
    s_waitcnt vmcnt(16)
    s_barrier
    s_add_u32 m0, s37, 118528
    s_mov_b32 s39, 286720
    buffer_load_dwordx4 v20, s[28:31], s39 offen lds
    s_add_u32 m0, s37, 126720
    s_mov_b32 s39, 688128
    buffer_load_dwordx4 v20, s[28:31], s39 offen lds
    s_add_u32 m0, s37, 134912
    s_mov_b32 s39, 1089536
    buffer_load_dwordx4 v20, s[28:31], s39 offen lds
    s_add_u32 m0, s49, 62464
    s_nop 0
    buffer_load_dwordx4 v6, s[24:27], s57 offen offset:640 lds
    s_add_u32 m0, s50, 62464
    s_nop 0
    buffer_load_dwordx4 v6, s[24:27], s58 offen offset:640 lds
    s_add_u32 m0, s51, 62464
    s_nop 0
    buffer_load_dwordx4 v6, s[24:27], s59 offen offset:640 lds
    s_add_u32 m0, s52, 62464
    s_nop 0
    buffer_load_dwordx4 v6, s[24:27], s60 offen offset:640 lds
    s_add_u32 m0, s53, 62464
    s_nop 0
    buffer_load_dwordx4 v6, s[24:27], s61 offen offset:640 lds
    s_add_u32 m0, s54, 62464
    s_nop 0
    buffer_load_dwordx4 v6, s[24:27], s62 offen offset:640 lds
    s_waitcnt vmcnt(14)
    s_barrier
    s_add_u32 m0, s37, 122624
    s_mov_b32 s39, 315392
    buffer_load_dwordx4 v20, s[28:31], s39 offen lds
    s_add_u32 m0, s37, 130816
    s_mov_b32 s39, 716800
    buffer_load_dwordx4 v20, s[28:31], s39 offen lds
    s_add_u32 m0, s37, 139008
    s_mov_b32 s39, 1118208
    buffer_load_dwordx4 v20, s[28:31], s39 offen lds
    s_add_u32 m0, s48, 384
    s_nop 0
    buffer_load_dwordx4 v6, s[24:27], s56 offen offset:768 lds
    s_add_u32 m0, s38, 256
    s_mov_b64 exec, s[72:73]
    buffer_load_dwordx4 v18, s[24:27], 0 offen offset:768 lds
    s_mov_b64 exec, -1
    s_waitcnt vmcnt(16)
    s_barrier
    s_add_u32 m0, s37, 93952
    s_mov_b32 s39, 344064
    buffer_load_dwordx4 v20, s[28:31], s39 offen lds
    s_add_u32 m0, s37, 102144
    s_mov_b32 s39, 745472
    buffer_load_dwordx4 v20, s[28:31], s39 offen lds
    s_add_u32 m0, s37, 110336
    s_mov_b32 s39, 1146880
    buffer_load_dwordx4 v20, s[28:31], s39 offen lds
    s_add_u32 m0, s49, 384
    s_nop 0
    buffer_load_dwordx4 v6, s[24:27], s57 offen offset:768 lds
    s_add_u32 m0, s50, 384
    s_nop 0
    buffer_load_dwordx4 v6, s[24:27], s58 offen offset:768 lds
    s_add_u32 m0, s51, 384
    s_nop 0
    buffer_load_dwordx4 v6, s[24:27], s59 offen offset:768 lds
    s_add_u32 m0, s52, 384
    s_nop 0
    buffer_load_dwordx4 v6, s[24:27], s60 offen offset:768 lds
    s_add_u32 m0, s53, 384
    s_nop 0
    buffer_load_dwordx4 v6, s[24:27], s61 offen offset:768 lds
    s_add_u32 m0, s54, 384
    s_nop 0
    buffer_load_dwordx4 v6, s[24:27], s62 offen offset:768 lds
    s_waitcnt vmcnt(14)
    s_barrier
    s_add_u32 m0, s37, 98048
    s_mov_b32 s39, 372736
    buffer_load_dwordx4 v20, s[28:31], s39 offen lds
    s_add_u32 m0, s37, 106240
    s_mov_b32 s39, 774144
    buffer_load_dwordx4 v20, s[28:31], s39 offen lds
    s_add_u32 m0, s37, 114432
    s_mov_b32 s39, 1175552
    buffer_load_dwordx4 v20, s[28:31], s39 offen lds
    v_lshl_add_u32 v1, v0, 1, s68
    s_waitcnt lgkmcnt(0)
    global_load_ushort v32, v1, s[8:9]
    global_load_ushort v33, v1, s[10:11]
    global_load_ushort v34, v1, s[12:13]
    global_load_ushort v35, v1, s[14:15]
    s_waitcnt vmcnt(18)
    s_barrier
    s_waitcnt vmcnt(7)
    s_barrier
    s_setprio 2
    s_waitcnt vmcnt(0)
    v_lshlrev_b32 v32, 16, v32
    v_lshlrev_b32 v33, 16, v33
    v_lshlrev_b32 v34, 16, v34
    v_lshlrev_b32 v35, 16, v35
    v_add_f32 v33, 0x3727c5ac, v33
    v_cvt_pk_bf16_f32 v33, v33, v33
    v_lshlrev_b32 v33, 16, v33
    v_sqrt_f32 v33, v33
    s_nop 0
    v_cvt_pk_bf16_f32 v33, v33, v33
    v_lshlrev_b32 v33, 16, v33
    v_rcp_f32 v33, v33
    s_nop 0
    v_cvt_pk_bf16_f32 v33, v33, v33
    v_lshlrev_b32 v33, 16, v33
    v_mul_f32 v33, v34, v33
    v_cvt_pk_bf16_f32 v33, v33, v33
    v_lshlrev_b32 v33, 16, v33
    v_fma_f32 v35, -v32, v33, v35
    v_mul_f32 v33, 0xbfb8aa3b, v33
    v_mul_f32 v35, 0xbfb8aa3b, v35
    v_lshlrev_b32 v1, 2, v0
    ds_write_b32 v1, v33
    ds_write_b32 v1, v35 offset:256
    s_waitcnt lgkmcnt(0)
    s_waitcnt vmcnt(4)
    s_barrier
    s_endpgm
L_help:
    s_cmp_ge_u32 s2, 256
    s_cbranch_scc1 L_end
    s_sub_u32 s22, s22, 28
    s_lshl2_add_u32 s19, s70, s22
    s_add_u32 s18, s71, 1920
    s_mov_b32 s69, 0
    s_cmp_ge_u32 s20, 4
    s_cbranch_scc1 L_hc2
    s_mul_i32 s23, s19, 240
    s_add_u32 s23, s23, s71
    s_mul_i32 s44, s20, 60
    s_add_u32 s23, s23, s44
    v_min_u32 v2, 59, v0
    v_add_u32 v2, s23, v2
    v_mul_u32_u24 v2, 896, v2
    s_sub_u32 s23, s2, 224
    s_lshl2_add_u32 s23, s23, s20
    s_mul_i32 s23, s23, 11
    v_add_u32 v3, s23, v0
    v_min_u32 v3, 1343, v3
    v_mul_u32_u24 v4, 9363, v3
    v_lshrrev_b32 v4, 22, v4
    v_mul_u32_u24 v4, 2688, v4
    v_add_u32 v3, v3, v4
    v_lshlrev_b32 v3, 7, v3
    s_mov_b32 s26, 7340032
    s_mov_b32 s27, 0x20000
    s_mov_b32 s30, 1204224
    s_mov_b32 s31, 0x20000
    s_waitcnt lgkmcnt(0)
    s_mov_b32 s24, s4
    s_mov_b32 s25, s5
    s_mov_b32 s28, s6
    s_mov_b32 s29, s7
    s_mov_b64 exec, 0x7ff
    s_mov_b32 s39, 0
    buffer_load_dword v41, v3, s[28:31], s39 offen
    s_mov_b64 exec, -1
    s_mov_b64 exec, 0x7ff
    s_mov_b32 s39, 57344
    buffer_load_dword v41, v3, s[28:31], s39 offen
    s_mov_b64 exec, -1
    s_mov_b64 exec, 0x7ff
    s_mov_b32 s39, 114688
    buffer_load_dword v41, v3, s[28:31], s39 offen
    s_mov_b64 exec, -1
    buffer_load_dword v40, v2, s[24:27], 0 offen offset:128
    buffer_load_dword v40, v2, s[24:27], 0 offen offset:256
    s_mov_b64 exec, 0x7ff
    s_mov_b32 s39, 172032
    buffer_load_dword v41, v3, s[28:31], s39 offen
    s_mov_b64 exec, -1
    s_lshl2_add_u32 s23, s19, s20
    s_mul_i32 s23, s23, 3712
    s_mul_i32 s39, s18, 896
    s_sub_u32 s39, s39, 896
    v_lshl_add_u32 v9, v0, 7, s23
    s_mov_b64 exec, 0x1fffffff
    buffer_load_dword v43, v9, s[24:27], s39 offen
    s_mov_b64 exec, -1
    s_mov_b64 exec, 0x7ff
    s_mov_b32 s39, 229376
    buffer_load_dword v41, v3, s[28:31], s39 offen
    s_mov_b64 exec, -1
    s_mov_b64 exec, 0x7ff
    s_mov_b32 s39, 286720
    buffer_load_dword v41, v3, s[28:31], s39 offen
    s_mov_b64 exec, -1
    s_mov_b64 exec, 0x7ff
    s_mov_b32 s39, 344064
    buffer_load_dword v41, v3, s[28:31], s39 offen
    s_mov_b64 exec, -1
    s_load_dwordx8 s[8:15], s[0:1], 16
    v_and_b32 v9, 7, v0
    v_min_u32 v9, 6, v9
    v_lshlrev_b32 v9, 7, v9
    s_waitcnt lgkmcnt(0)
    global_load_ushort v42, v9, s[8:9]
    global_load_ushort v42, v9, s[10:11]
    global_load_ushort v42, v9, s[12:13]
    global_load_ushort v42, v9, s[14:15]
    s_cmp_eq_u32 s19, 7
    s_cbranch_scc0 L_sload
    s_endpgm
L_help0:
    s_cmp_ge_u32 s2, 256
    s_cbranch_scc1 L_help
    s_getpc_b64 s[50:51]
L_pc:
    s_sub_u32 s50, s50, L_pc - standalone__batchnorm__prompt_kernel
    s_subb_u32 s51, s51, 0
    s_and_b32 s23, s22, 3
    s_lshl_b32 s23, s23, 7
    v_lshl_add_u32 v2, v0, 9, s23
    v_min_u32 v2, L_end - standalone__batchnorm__prompt_kernel, v2
    v_mov_b32 v3, s51
    v_add_co_u32 v2, vcc, s50, v2
    s_nop 1
    v_addc_co_u32 v3, vcc, 0, v3, vcc
    global_load_dword v30, v[2:3], off
    s_branch L_help
L_compute:
    s_load_dwordx2 s[16:17], s[0:1], 48
    s_sub_u32 s21, s20, 4
    v_and_b32 v6, 15, v0
    v_lshrrev_b32 v7, 4, v0
    v_add_u32 v8, -1, v6
    v_bfe_u32 v10, v8, 1, 1
    v_bfe_u32 v8, v8, 2, 1
    v_lshlrev_b32 v8, 1, v8
    v_lshl_or_b32 v8, v10, 2, v8
    v_xor_b32 v8, v8, v7
    v_lshlrev_b32 v8, 4, v8
    v_lshl_add_u32 v20, v6, 7, v8
    v_add_u32 v20, 1024, v20
    v_xor_b32 v21, 64, v20
    v_mov_b32 v8, v6
    v_bfe_u32 v10, v8, 1, 1
    v_bfe_u32 v8, v8, 2, 1
    v_lshlrev_b32 v8, 1, v8
    v_lshl_or_b32 v8, v10, 2, v8
    v_xor_b32 v8, v8, v7
    v_lshlrev_b32 v8, 4, v8
    v_lshl_add_u32 v22, v6, 7, v8
    v_add_u32 v22, 1152, v22
    v_xor_b32 v23, 64, v22
    v_add_u32 v8, 1, v6
    v_bfe_u32 v10, v8, 1, 1
    v_bfe_u32 v8, v8, 2, 1
    v_lshlrev_b32 v8, 1, v8
    v_lshl_or_b32 v8, v10, 2, v8
    v_xor_b32 v8, v8, v7
    v_lshlrev_b32 v8, 4, v8
    v_lshl_add_u32 v24, v6, 7, v8
    v_add_u32 v24, 1280, v24
    v_xor_b32 v25, 64, v24
    v_bfe_u32 v8, v0, 2, 2
    v_lshl_add_u32 v9, v7, 3, v8
    v_lshlrev_b32 v9, 7, v9
    v_bfe_u32 v10, v0, 3, 2
    v_xor_b32 v10, s21, v10
    v_lshl_add_u32 v9, v10, 5, v9
    v_and_b32 v10, 3, v0
    v_lshl_add_u32 v9, v10, 3, v9
    v_add_u32 v26, 93952, v9
    v_mov_b64 v[32:33], 0
    v_mov_b64 v[34:35], 0
    v_mov_b64 v[36:37], 0
    v_mov_b64 v[38:39], 0
    v_mov_b64 v[40:41], 0
    v_mov_b64 v[42:43], 0
    v_mov_b64 v[44:45], 0
    v_mov_b64 v[46:47], 0
    v_mov_b64 v[48:49], 0
    v_mov_b64 v[50:51], 0
    v_mov_b64 v[52:53], 0
    v_mov_b64 v[54:55], 0
    v_mov_b64 v[56:57], 0
    v_mov_b64 v[58:59], 0
    v_mov_b64 v[60:61], 0
    v_mov_b64 v[62:63], 0
    v_mov_b64 v[64:65], 0
    v_mov_b64 v[66:67], 0
    v_mov_b64 v[68:69], 0
    v_mov_b64 v[70:71], 0
    v_mov_b64 v[72:73], 0
    v_mov_b64 v[74:75], 0
    v_mov_b64 v[76:77], 0
    v_mov_b64 v[78:79], 0
    v_mov_b64 v[80:81], 0
    v_mov_b64 v[82:83], 0
    v_mov_b64 v[84:85], 0
    v_mov_b64 v[86:87], 0
    v_mov_b64 v[88:89], 0
    v_mov_b64 v[90:91], 0
    s_lshl_b32 s22, s21, 5
    s_add_u32 s22, s22, 143104
    v_mul_u32_u24 v9, 272, v6
    v_lshl_add_u32 v9, v7, 3, v9
    v_add_u32 v10, s22, v9
    s_lshl_b32 s22, s21, 2
    v_add_u32 v14, s22, v7
    v_mul_u32_u24 v15, 272, v14
    v_lshl_add_u32 v15, v6, 4, v15
    v_add_u32 v15, 143104, v15
    v_bfe_u32 v8, v0, 3, 1
    v_mad_u32_u24 v16, v14, 15, v8
    v_mul_u32_u24 v16, 896, v16
    v_and_b32 v8, 7, v0
    v_lshl_add_u32 v16, v8, 4, v16
    v_lshlrev_b32 v17, 4, v14
    s_mul_i32 s22, s18, 896
    s_lshl_b32 s23, s19, 7
    s_add_u32 s22, s22, s23
    s_sub_u32 s34, 215040, s23
    s_mov_b32 s35, 0x20000
    s_mov_b32 s40, 0
    s_mov_b32 s41, 30976
    s_mov_b32 s42, 24576
    s_mov_b32 s44, 0xbfb8aa3b
    s_mov_b32 s45, 0xbfb8aa3b
    s_mov_b32 s46, 30976
    s_mov_b32 s47, 4294905344
    s_waitcnt lgkmcnt(0)
    s_add_u32 s32, s16, s22
    s_addc_u32 s33, s17, 0
L_pg2:
    s_setprio 1
    s_barrier
    ds_read_b64_tr_b16 v[160:161], v26 offset:0
    ds_read_b64_tr_b16 v[162:163], v26 offset:512
    ds_read_b64_tr_b16 v[164:165], v26 offset:8192
    ds_read_b64_tr_b16 v[166:167], v26 offset:8704
    ds_read_b64_tr_b16 v[168:169], v26 offset:16384
    ds_read_b64_tr_b16 v[170:171], v26 offset:16896
    ds_read_b128 v[92:95], v20 offset:0
    ds_read_b128 v[96:99], v22 offset:28672
    ds_read_b128 v[100:103], v22 offset:26624
    ds_read_b128 v[104:107], v22 offset:24576
    ds_read_b128 v[108:111], v22 offset:22528
    ds_read_b128 v[112:115], v22 offset:20480
    ds_read_b128 v[116:119], v22 offset:18432
L_loop:
    s_waitcnt lgkmcnt(3)
    v_mfma_f32_16x16x32_bf16 v[32:35], v[160:163], v[92:95], v[32:35]
    ds_read_b128 v[120:123], v22 offset:16384
    v_mfma_f32_16x16x32_bf16 v[32:35], v[164:167], v[96:99], v[32:35]
    ds_read_b128 v[124:127], v22 offset:14336
    v_mfma_f32_16x16x32_bf16 v[32:35], v[168:171], v[100:103], v[32:35]
    ds_read_b128 v[128:131], v22 offset:12288
    v_mfma_f32_16x16x32_bf16 v[36:39], v[168:171], v[104:107], v[36:39]
    ds_read_b128 v[132:135], v22 offset:10240
    v_mfma_f32_16x16x32_bf16 v[36:39], v[164:167], v[100:103], v[36:39]
    ds_read_b128 v[136:139], v22 offset:8192
    v_mfma_f32_16x16x32_bf16 v[36:39], v[160:163], v[96:99], v[36:39]
    ds_read_b128 v[140:143], v22 offset:6144
    s_waitcnt lgkmcnt(6)
    v_mfma_f32_16x16x32_bf16 v[40:43], v[160:163], v[100:103], v[40:43]
    ds_read_b128 v[144:147], v22 offset:4096
    v_mfma_f32_16x16x32_bf16 v[40:43], v[164:167], v[104:107], v[40:43]
    ds_read_b128 v[148:151], v22 offset:2048
    v_mfma_f32_16x16x32_bf16 v[40:43], v[168:171], v[108:111], v[40:43]
    ds_read_b128 v[152:155], v22 offset:0
    v_mfma_f32_16x16x32_bf16 v[44:47], v[168:171], v[112:115], v[44:47]
    ds_read_b128 v[156:159], v24 offset:28672
    v_mfma_f32_16x16x32_bf16 v[44:47], v[164:167], v[108:111], v[44:47]
    v_add_u32 v20, s41, v20
    v_mfma_f32_16x16x32_bf16 v[44:47], v[160:163], v[104:107], v[44:47]
    v_add_u32 v22, s41, v22
    v_mfma_f32_16x16x32_bf16 v[48:51], v[160:163], v[108:111], v[48:51]
    v_add_u32 v24, s41, v24
    v_mfma_f32_16x16x32_bf16 v[48:51], v[164:167], v[112:115], v[48:51]
    s_add_u32 s40, s40, 1
    v_mfma_f32_16x16x32_bf16 v[48:51], v[168:171], v[116:119], v[48:51]
    s_waitcnt lgkmcnt(0)
    v_mfma_f32_16x16x32_bf16 v[52:55], v[168:171], v[120:123], v[52:55]
    v_mfma_f32_16x16x32_bf16 v[52:55], v[164:167], v[116:119], v[52:55]
    v_mfma_f32_16x16x32_bf16 v[52:55], v[160:163], v[112:115], v[52:55]
    v_mfma_f32_16x16x32_bf16 v[56:59], v[160:163], v[116:119], v[56:59]
    v_mfma_f32_16x16x32_bf16 v[56:59], v[164:167], v[120:123], v[56:59]
    v_mfma_f32_16x16x32_bf16 v[56:59], v[168:171], v[124:127], v[56:59]
    v_mfma_f32_16x16x32_bf16 v[60:63], v[168:171], v[128:131], v[60:63]
    v_mfma_f32_16x16x32_bf16 v[60:63], v[164:167], v[124:127], v[60:63]
    v_mfma_f32_16x16x32_bf16 v[60:63], v[160:163], v[120:123], v[60:63]
    v_mfma_f32_16x16x32_bf16 v[64:67], v[160:163], v[124:127], v[64:67]
    v_mfma_f32_16x16x32_bf16 v[64:67], v[164:167], v[128:131], v[64:67]
    v_mfma_f32_16x16x32_bf16 v[64:67], v[168:171], v[132:135], v[64:67]
    v_mfma_f32_16x16x32_bf16 v[68:71], v[168:171], v[136:139], v[68:71]
    v_mfma_f32_16x16x32_bf16 v[68:71], v[164:167], v[132:135], v[68:71]
    s_barrier
    v_mfma_f32_16x16x32_bf16 v[68:71], v[160:163], v[128:131], v[68:71]
    ds_read_b64_tr_b16 v[240:241], v26 offset:4096
    v_mfma_f32_16x16x32_bf16 v[72:75], v[160:163], v[132:135], v[72:75]
    ds_read_b64_tr_b16 v[242:243], v26 offset:4608
    v_mfma_f32_16x16x32_bf16 v[72:75], v[164:167], v[136:139], v[72:75]
    ds_read_b64_tr_b16 v[244:245], v26 offset:12288
    v_mfma_f32_16x16x32_bf16 v[72:75], v[168:171], v[140:143], v[72:75]
    ds_read_b64_tr_b16 v[246:247], v26 offset:12800
    v_mfma_f32_16x16x32_bf16 v[76:79], v[168:171], v[144:147], v[76:79]
    ds_read_b64_tr_b16 v[248:249], v26 offset:20480
    v_mfma_f32_16x16x32_bf16 v[76:79], v[164:167], v[140:143], v[76:79]
    ds_read_b64_tr_b16 v[250:251], v26 offset:20992
    v_mfma_f32_16x16x32_bf16 v[76:79], v[160:163], v[136:139], v[76:79]
    ds_read_b128 v[172:175], v21 offset:0
    v_mfma_f32_16x16x32_bf16 v[80:83], v[160:163], v[140:143], v[80:83]
    ds_read_b128 v[176:179], v23 offset:28672
    v_mfma_f32_16x16x32_bf16 v[80:83], v[164:167], v[144:147], v[80:83]
    ds_read_b128 v[180:183], v23 offset:26624
    v_mfma_f32_16x16x32_bf16 v[80:83], v[168:171], v[148:151], v[80:83]
    ds_read_b128 v[184:187], v23 offset:24576
    v_mfma_f32_16x16x32_bf16 v[84:87], v[168:171], v[152:155], v[84:87]
    ds_read_b128 v[188:191], v23 offset:22528
    v_mfma_f32_16x16x32_bf16 v[84:87], v[164:167], v[148:151], v[84:87]
    ds_read_b128 v[192:195], v23 offset:20480
    v_mfma_f32_16x16x32_bf16 v[84:87], v[160:163], v[144:147], v[84:87]
    ds_read_b128 v[196:199], v23 offset:18432
    v_mfma_f32_16x16x32_bf16 v[88:91], v[160:163], v[148:151], v[88:91]
    v_mfma_f32_16x16x32_bf16 v[88:91], v[164:167], v[152:155], v[88:91]
    s_cmp_lt_u32 s40, 7
    v_mfma_f32_16x16x32_bf16 v[88:91], v[168:171], v[156:159], v[88:91]
    s_cbranch_scc0 L_tail
    s_waitcnt lgkmcnt(3)
    v_mfma_f32_16x16x32_bf16 v[32:35], v[240:243], v[172:175], v[32:35]
    ds_read_b128 v[200:203], v23 offset:16384
    v_mfma_f32_16x16x32_bf16 v[32:35], v[244:247], v[176:179], v[32:35]
    ds_read_b128 v[204:207], v23 offset:14336
    v_mfma_f32_16x16x32_bf16 v[32:35], v[248:251], v[180:183], v[32:35]
    ds_read_b128 v[208:211], v23 offset:12288
    v_mfma_f32_16x16x32_bf16 v[36:39], v[248:251], v[184:187], v[36:39]
    ds_read_b128 v[212:215], v23 offset:10240
    v_mfma_f32_16x16x32_bf16 v[36:39], v[244:247], v[180:183], v[36:39]
    ds_read_b128 v[216:219], v23 offset:8192
    v_mfma_f32_16x16x32_bf16 v[36:39], v[240:243], v[176:179], v[36:39]
    ds_read_b128 v[220:223], v23 offset:6144
    s_waitcnt lgkmcnt(6)
    v_mfma_f32_16x16x32_bf16 v[40:43], v[240:243], v[180:183], v[40:43]
    ds_read_b128 v[224:227], v23 offset:4096
    v_mfma_f32_16x16x32_bf16 v[40:43], v[244:247], v[184:187], v[40:43]
    ds_read_b128 v[228:231], v23 offset:2048
    v_mfma_f32_16x16x32_bf16 v[40:43], v[248:251], v[188:191], v[40:43]
    ds_read_b128 v[232:235], v23 offset:0
    v_mfma_f32_16x16x32_bf16 v[44:47], v[248:251], v[192:195], v[44:47]
    ds_read_b128 v[236:239], v25 offset:28672
    v_mfma_f32_16x16x32_bf16 v[44:47], v[244:247], v[188:191], v[44:47]
    v_add_u32 v21, s41, v21
    v_mfma_f32_16x16x32_bf16 v[44:47], v[240:243], v[184:187], v[44:47]
    v_add_u32 v23, s41, v23
    v_mfma_f32_16x16x32_bf16 v[48:51], v[240:243], v[188:191], v[48:51]
    v_add_u32 v25, s41, v25
    v_mfma_f32_16x16x32_bf16 v[48:51], v[244:247], v[192:195], v[48:51]
    v_add_u32 v26, s42, v26
    v_mfma_f32_16x16x32_bf16 v[48:51], v[248:251], v[196:199], v[48:51]
    s_sub_u32 s42, 0, s42
    s_waitcnt lgkmcnt(0)
    v_mfma_f32_16x16x32_bf16 v[52:55], v[248:251], v[200:203], v[52:55]
    v_mfma_f32_16x16x32_bf16 v[52:55], v[244:247], v[196:199], v[52:55]
    v_mfma_f32_16x16x32_bf16 v[52:55], v[240:243], v[192:195], v[52:55]
    v_mfma_f32_16x16x32_bf16 v[56:59], v[240:243], v[196:199], v[56:59]
    v_mfma_f32_16x16x32_bf16 v[56:59], v[244:247], v[200:203], v[56:59]
    v_mfma_f32_16x16x32_bf16 v[56:59], v[248:251], v[204:207], v[56:59]
    v_mfma_f32_16x16x32_bf16 v[60:63], v[248:251], v[208:211], v[60:63]
    v_mfma_f32_16x16x32_bf16 v[60:63], v[244:247], v[204:207], v[60:63]
    v_mfma_f32_16x16x32_bf16 v[60:63], v[240:243], v[200:203], v[60:63]
    v_mfma_f32_16x16x32_bf16 v[64:67], v[240:243], v[204:207], v[64:67]
    v_mfma_f32_16x16x32_bf16 v[64:67], v[244:247], v[208:211], v[64:67]
    v_mfma_f32_16x16x32_bf16 v[64:67], v[248:251], v[212:215], v[64:67]
    v_mfma_f32_16x16x32_bf16 v[68:71], v[248:251], v[216:219], v[68:71]
    v_mfma_f32_16x16x32_bf16 v[68:71], v[244:247], v[212:215], v[68:71]
    s_barrier
    v_mfma_f32_16x16x32_bf16 v[68:71], v[240:243], v[208:211], v[68:71]
    ds_read_b64_tr_b16 v[160:161], v26 offset:0
    v_mfma_f32_16x16x32_bf16 v[72:75], v[240:243], v[212:215], v[72:75]
    ds_read_b64_tr_b16 v[162:163], v26 offset:512
    v_mfma_f32_16x16x32_bf16 v[72:75], v[244:247], v[216:219], v[72:75]
    ds_read_b64_tr_b16 v[164:165], v26 offset:8192
    v_mfma_f32_16x16x32_bf16 v[72:75], v[248:251], v[220:223], v[72:75]
    ds_read_b64_tr_b16 v[166:167], v26 offset:8704
    v_mfma_f32_16x16x32_bf16 v[76:79], v[248:251], v[224:227], v[76:79]
    ds_read_b64_tr_b16 v[168:169], v26 offset:16384
    v_mfma_f32_16x16x32_bf16 v[76:79], v[244:247], v[220:223], v[76:79]
    ds_read_b64_tr_b16 v[170:171], v26 offset:16896
    v_mfma_f32_16x16x32_bf16 v[76:79], v[240:243], v[216:219], v[76:79]
    ds_read_b128 v[92:95], v20 offset:0
    v_mfma_f32_16x16x32_bf16 v[80:83], v[240:243], v[220:223], v[80:83]
    ds_read_b128 v[96:99], v22 offset:28672
    v_mfma_f32_16x16x32_bf16 v[80:83], v[244:247], v[224:227], v[80:83]
    ds_read_b128 v[100:103], v22 offset:26624
    v_mfma_f32_16x16x32_bf16 v[80:83], v[248:251], v[228:231], v[80:83]
    ds_read_b128 v[104:107], v22 offset:24576
    v_mfma_f32_16x16x32_bf16 v[84:87], v[248:251], v[232:235], v[84:87]
    ds_read_b128 v[108:111], v22 offset:22528
    v_mfma_f32_16x16x32_bf16 v[84:87], v[244:247], v[228:231], v[84:87]
    ds_read_b128 v[112:115], v22 offset:20480
    v_mfma_f32_16x16x32_bf16 v[84:87], v[240:243], v[224:227], v[84:87]
    ds_read_b128 v[116:119], v22 offset:18432
    v_mfma_f32_16x16x32_bf16 v[88:91], v[240:243], v[228:231], v[88:91]
    s_cmp_eq_u32 s40, 2
    s_cselect_b32 s43, 5, s40
    v_mfma_f32_16x16x32_bf16 v[88:91], v[244:247], v[232:235], v[88:91]
    s_cmp_eq_u32 s43, 5
    s_cselect_b32 s41, s47, s46
    v_mfma_f32_16x16x32_bf16 v[88:91], v[248:251], v[236:239], v[88:91]
    s_branch L_loop
L_tail:
    s_waitcnt lgkmcnt(3)
    v_mfma_f32_16x16x32_bf16 v[32:35], v[240:243], v[172:175], v[32:35]
    ds_read_b128 v[92:95], v17
    v_mfma_f32_16x16x32_bf16 v[32:35], v[244:247], v[176:179], v[32:35]
    ds_read_b128 v[96:99], v17 offset:256
    v_add_u32 v11, 4352, v10
    v_mfma_f32_16x16x32_bf16 v[32:35], v[248:251], v[180:183], v[32:35]
    ds_read_b128 v[200:203], v23 offset:16384
    v_mfma_f32_16x16x32_bf16 v[36:39], v[248:251], v[184:187], v[36:39]
    ds_read_b128 v[204:207], v23 offset:14336
    v_mfma_f32_16x16x32_bf16 v[36:39], v[244:247], v[180:183], v[36:39]
    ds_read_b128 v[208:211], v23 offset:12288
    v_mfma_f32_16x16x32_bf16 v[36:39], v[240:243], v[176:179], v[36:39]
    ds_read_b128 v[212:215], v23 offset:10240
    s_waitcnt lgkmcnt(6)
    v_mfma_f32_16x16x32_bf16 v[40:43], v[240:243], v[180:183], v[40:43]
    ds_read_b128 v[216:219], v23 offset:8192
    v_mfma_f32_16x16x32_bf16 v[40:43], v[244:247], v[184:187], v[40:43]
    ds_read_b128 v[220:223], v23 offset:6144
    v_mfma_f32_16x16x32_bf16 v[40:43], v[248:251], v[188:191], v[40:43]
    ds_read_b128 v[224:227], v23 offset:4096
    v_mfma_f32_16x16x32_bf16 v[44:47], v[248:251], v[192:195], v[44:47]
    ds_read_b128 v[228:231], v23 offset:2048
    v_mfma_f32_16x16x32_bf16 v[44:47], v[244:247], v[188:191], v[44:47]
    ds_read_b128 v[232:235], v23 offset:0
    v_mfma_f32_16x16x32_bf16 v[44:47], v[240:243], v[184:187], v[44:47]
    ds_read_b128 v[236:239], v25 offset:28672
    s_waitcnt lgkmcnt(10)
    v_pk_fma_f32 v[32:33], v[32:33], v[92:93], v[96:97]
    v_pk_fma_f32 v[34:35], v[34:35], v[94:95], v[98:99]
    v_pk_fma_f32 v[36:37], v[36:37], v[92:93], v[96:97]
    v_pk_fma_f32 v[38:39], v[38:39], v[94:95], v[98:99]
    v_mfma_f32_16x16x32_bf16 v[48:51], v[240:243], v[188:191], v[48:51]
    v_exp_f32 v100, v32
    v_exp_f32 v101, v33
    v_mfma_f32_16x16x32_bf16 v[48:51], v[244:247], v[192:195], v[48:51]
    v_exp_f32 v102, v34
    v_exp_f32 v103, v35
    v_mfma_f32_16x16x32_bf16 v[48:51], v[248:251], v[196:199], v[48:51]
    v_exp_f32 v104, v36
    v_exp_f32 v105, v37
    v_exp_f32 v106, v38
    v_exp_f32 v107, v39
    v_pk_fma_f32 v[100:101], v[100:101], s[44:45], s[44:45]
    v_pk_fma_f32 v[102:103], v[102:103], s[44:45], s[44:45]
    v_pk_fma_f32 v[104:105], v[104:105], s[44:45], s[44:45]
    v_pk_fma_f32 v[106:107], v[106:107], s[44:45], s[44:45]
    s_waitcnt lgkmcnt(0)
    v_mfma_f32_16x16x32_bf16 v[52:55], v[248:251], v[200:203], v[52:55]
    v_rcp_f32 v100, v100
    v_rcp_f32 v101, v101
    v_mfma_f32_16x16x32_bf16 v[52:55], v[244:247], v[196:199], v[52:55]
    v_rcp_f32 v102, v102
    v_rcp_f32 v103, v103
    v_mfma_f32_16x16x32_bf16 v[52:55], v[240:243], v[192:195], v[52:55]
    v_rcp_f32 v104, v104
    v_rcp_f32 v105, v105
    v_rcp_f32 v106, v106
    v_rcp_f32 v107, v107
    v_pk_mul_f32 v[32:33], v[32:33], v[100:101]
    v_pk_mul_f32 v[34:35], v[34:35], v[102:103]
    v_pk_mul_f32 v[36:37], v[36:37], v[104:105]
    v_pk_mul_f32 v[38:39], v[38:39], v[106:107]
    v_cvt_pk_bf16_f32 v116, v32, v33
    v_cvt_pk_bf16_f32 v117, v34, v35
    v_cvt_pk_bf16_f32 v118, v36, v37
    v_cvt_pk_bf16_f32 v119, v38, v39
    v_pk_fma_f32 v[40:41], v[40:41], v[92:93], v[96:97]
    v_pk_fma_f32 v[42:43], v[42:43], v[94:95], v[98:99]
    v_pk_fma_f32 v[44:45], v[44:45], v[92:93], v[96:97]
    v_pk_fma_f32 v[46:47], v[46:47], v[94:95], v[98:99]
    v_mfma_f32_16x16x32_bf16 v[56:59], v[240:243], v[196:199], v[56:59]
    v_exp_f32 v108, v40
    ds_write2_b64 v10, v[116:117], v[118:119] offset1:16
    v_exp_f32 v109, v41
    v_mfma_f32_16x16x32_bf16 v[56:59], v[244:247], v[200:203], v[56:59]
    v_exp_f32 v110, v42
    v_exp_f32 v111, v43
    v_mfma_f32_16x16x32_bf16 v[56:59], v[248:251], v[204:207], v[56:59]
    v_exp_f32 v112, v44
    v_exp_f32 v113, v45
    v_exp_f32 v114, v46
    v_exp_f32 v115, v47
    v_pk_fma_f32 v[108:109], v[108:109], s[44:45], s[44:45]
    v_pk_fma_f32 v[110:111], v[110:111], s[44:45], s[44:45]
    v_pk_fma_f32 v[112:113], v[112:113], s[44:45], s[44:45]
    v_pk_fma_f32 v[114:115], v[114:115], s[44:45], s[44:45]
    v_mfma_f32_16x16x32_bf16 v[60:63], v[248:251], v[208:211], v[60:63]
    v_rcp_f32 v108, v108
    v_rcp_f32 v109, v109
    v_mfma_f32_16x16x32_bf16 v[60:63], v[244:247], v[204:207], v[60:63]
    v_rcp_f32 v110, v110
    v_rcp_f32 v111, v111
    v_mfma_f32_16x16x32_bf16 v[60:63], v[240:243], v[200:203], v[60:63]
    v_rcp_f32 v112, v112
    s_waitcnt lgkmcnt(0)
    s_barrier
    ds_read_b128 v[124:127], v15 offset:0
    v_rcp_f32 v113, v113
    v_rcp_f32 v114, v114
    v_rcp_f32 v115, v115
    v_pk_mul_f32 v[40:41], v[40:41], v[108:109]
    v_pk_mul_f32 v[42:43], v[42:43], v[110:111]
    v_pk_mul_f32 v[44:45], v[44:45], v[112:113]
    v_pk_mul_f32 v[46:47], v[46:47], v[114:115]
    v_cvt_pk_bf16_f32 v120, v40, v41
    v_cvt_pk_bf16_f32 v121, v42, v43
    v_cvt_pk_bf16_f32 v122, v44, v45
    v_cvt_pk_bf16_f32 v123, v46, v47
    v_pk_fma_f32 v[48:49], v[48:49], v[92:93], v[96:97]
    v_pk_fma_f32 v[50:51], v[50:51], v[94:95], v[98:99]
    v_pk_fma_f32 v[52:53], v[52:53], v[92:93], v[96:97]
    v_pk_fma_f32 v[54:55], v[54:55], v[94:95], v[98:99]
    v_mfma_f32_16x16x32_bf16 v[64:67], v[240:243], v[204:207], v[64:67]
    s_waitcnt lgkmcnt(0)
    s_movk_i32 s48, 0
    buffer_store_dwordx4 v[124:127], v16, s[32:35], s48 offen sc1
    v_exp_f32 v100, v48
    ds_write2_b64 v11, v[120:121], v[122:123] offset1:16
    v_exp_f32 v101, v49
    v_mfma_f32_16x16x32_bf16 v[64:67], v[244:247], v[208:211], v[64:67]
    v_exp_f32 v102, v50
    v_exp_f32 v103, v51
    v_mfma_f32_16x16x32_bf16 v[64:67], v[248:251], v[212:215], v[64:67]
    v_exp_f32 v104, v52
    v_exp_f32 v105, v53
    v_exp_f32 v106, v54
    v_exp_f32 v107, v55
    v_pk_fma_f32 v[100:101], v[100:101], s[44:45], s[44:45]
    v_pk_fma_f32 v[102:103], v[102:103], s[44:45], s[44:45]
    v_pk_fma_f32 v[104:105], v[104:105], s[44:45], s[44:45]
    v_pk_fma_f32 v[106:107], v[106:107], s[44:45], s[44:45]
    v_mfma_f32_16x16x32_bf16 v[68:71], v[248:251], v[216:219], v[68:71]
    v_rcp_f32 v100, v100
    v_rcp_f32 v101, v101
    v_mfma_f32_16x16x32_bf16 v[68:71], v[244:247], v[212:215], v[68:71]
    v_rcp_f32 v102, v102
    v_rcp_f32 v103, v103
    v_mfma_f32_16x16x32_bf16 v[68:71], v[240:243], v[208:211], v[68:71]
    v_rcp_f32 v104, v104
    s_waitcnt lgkmcnt(0)
    s_barrier
    ds_read_b128 v[128:131], v15 offset:4352
    v_rcp_f32 v105, v105
    v_rcp_f32 v106, v106
    v_rcp_f32 v107, v107
    v_pk_mul_f32 v[48:49], v[48:49], v[100:101]
    v_pk_mul_f32 v[50:51], v[50:51], v[102:103]
    v_pk_mul_f32 v[52:53], v[52:53], v[104:105]
    v_pk_mul_f32 v[54:55], v[54:55], v[106:107]
    v_cvt_pk_bf16_f32 v116, v48, v49
    v_cvt_pk_bf16_f32 v117, v50, v51
    v_cvt_pk_bf16_f32 v118, v52, v53
    v_cvt_pk_bf16_f32 v119, v54, v55
    v_pk_fma_f32 v[56:57], v[56:57], v[92:93], v[96:97]
    v_pk_fma_f32 v[58:59], v[58:59], v[94:95], v[98:99]
    v_pk_fma_f32 v[60:61], v[60:61], v[92:93], v[96:97]
    v_pk_fma_f32 v[62:63], v[62:63], v[94:95], v[98:99]
    v_mfma_f32_16x16x32_bf16 v[72:75], v[240:243], v[212:215], v[72:75]
    s_waitcnt lgkmcnt(0)
    s_movk_i32 s48, 1792
    buffer_store_dwordx4 v[128:131], v16, s[32:35], s48 offen sc1
    v_exp_f32 v108, v56
    ds_write2_b64 v10, v[116:117], v[118:119] offset1:16
    v_exp_f32 v109, v57
    v_mfma_f32_16x16x32_bf16 v[72:75], v[244:247], v[216:219], v[72:75]
    v_exp_f32 v110, v58
    v_exp_f32 v111, v59
    v_mfma_f32_16x16x32_bf16 v[72:75], v[248:251], v[220:223], v[72:75]
    v_exp_f32 v112, v60
    v_exp_f32 v113, v61
    v_exp_f32 v114, v62
    v_exp_f32 v115, v63
    v_pk_fma_f32 v[108:109], v[108:109], s[44:45], s[44:45]
    v_pk_fma_f32 v[110:111], v[110:111], s[44:45], s[44:45]
    v_pk_fma_f32 v[112:113], v[112:113], s[44:45], s[44:45]
    v_pk_fma_f32 v[114:115], v[114:115], s[44:45], s[44:45]
    v_mfma_f32_16x16x32_bf16 v[76:79], v[248:251], v[224:227], v[76:79]
    v_rcp_f32 v108, v108
    v_rcp_f32 v109, v109
    v_mfma_f32_16x16x32_bf16 v[76:79], v[244:247], v[220:223], v[76:79]
    v_rcp_f32 v110, v110
    v_rcp_f32 v111, v111
    v_mfma_f32_16x16x32_bf16 v[76:79], v[240:243], v[216:219], v[76:79]
    v_rcp_f32 v112, v112
    s_waitcnt lgkmcnt(0)
    s_barrier
    ds_read_b128 v[124:127], v15 offset:0
    v_rcp_f32 v113, v113
    v_rcp_f32 v114, v114
    v_rcp_f32 v115, v115
    v_pk_mul_f32 v[56:57], v[56:57], v[108:109]
    v_pk_mul_f32 v[58:59], v[58:59], v[110:111]
    v_pk_mul_f32 v[60:61], v[60:61], v[112:113]
    v_pk_mul_f32 v[62:63], v[62:63], v[114:115]
    v_cvt_pk_bf16_f32 v120, v56, v57
    v_cvt_pk_bf16_f32 v121, v58, v59
    v_cvt_pk_bf16_f32 v122, v60, v61
    v_cvt_pk_bf16_f32 v123, v62, v63
    v_pk_fma_f32 v[64:65], v[64:65], v[92:93], v[96:97]
    v_pk_fma_f32 v[66:67], v[66:67], v[94:95], v[98:99]
    v_pk_fma_f32 v[68:69], v[68:69], v[92:93], v[96:97]
    v_pk_fma_f32 v[70:71], v[70:71], v[94:95], v[98:99]
    v_mfma_f32_16x16x32_bf16 v[80:83], v[240:243], v[220:223], v[80:83]
    s_waitcnt lgkmcnt(0)
    s_movk_i32 s48, 3584
    buffer_store_dwordx4 v[124:127], v16, s[32:35], s48 offen sc1
    v_exp_f32 v100, v64
    ds_write2_b64 v11, v[120:121], v[122:123] offset1:16
    v_exp_f32 v101, v65
    v_mfma_f32_16x16x32_bf16 v[80:83], v[244:247], v[224:227], v[80:83]
    v_exp_f32 v102, v66
    v_exp_f32 v103, v67
    v_mfma_f32_16x16x32_bf16 v[80:83], v[248:251], v[228:231], v[80:83]
    v_exp_f32 v104, v68
    v_exp_f32 v105, v69
    v_exp_f32 v106, v70
    v_exp_f32 v107, v71
    v_pk_fma_f32 v[100:101], v[100:101], s[44:45], s[44:45]
    v_pk_fma_f32 v[102:103], v[102:103], s[44:45], s[44:45]
    v_pk_fma_f32 v[104:105], v[104:105], s[44:45], s[44:45]
    v_pk_fma_f32 v[106:107], v[106:107], s[44:45], s[44:45]
    v_mfma_f32_16x16x32_bf16 v[84:87], v[248:251], v[232:235], v[84:87]
    v_rcp_f32 v100, v100
    v_rcp_f32 v101, v101
    v_mfma_f32_16x16x32_bf16 v[84:87], v[244:247], v[228:231], v[84:87]
    v_rcp_f32 v102, v102
    v_rcp_f32 v103, v103
    v_mfma_f32_16x16x32_bf16 v[84:87], v[240:243], v[224:227], v[84:87]
    v_rcp_f32 v104, v104
    s_waitcnt lgkmcnt(0)
    s_barrier
    ds_read_b128 v[128:131], v15 offset:4352
    v_rcp_f32 v105, v105
    v_rcp_f32 v106, v106
    v_rcp_f32 v107, v107
    v_pk_mul_f32 v[64:65], v[64:65], v[100:101]
    v_pk_mul_f32 v[66:67], v[66:67], v[102:103]
    v_pk_mul_f32 v[68:69], v[68:69], v[104:105]
    v_pk_mul_f32 v[70:71], v[70:71], v[106:107]
    v_cvt_pk_bf16_f32 v116, v64, v65
    v_cvt_pk_bf16_f32 v117, v66, v67
    v_cvt_pk_bf16_f32 v118, v68, v69
    v_cvt_pk_bf16_f32 v119, v70, v71
    v_pk_fma_f32 v[72:73], v[72:73], v[92:93], v[96:97]
    v_pk_fma_f32 v[74:75], v[74:75], v[94:95], v[98:99]
    v_pk_fma_f32 v[76:77], v[76:77], v[92:93], v[96:97]
    v_pk_fma_f32 v[78:79], v[78:79], v[94:95], v[98:99]
    v_mfma_f32_16x16x32_bf16 v[88:91], v[240:243], v[228:231], v[88:91]
    s_waitcnt lgkmcnt(0)
    s_movk_i32 s48, 5376
    buffer_store_dwordx4 v[128:131], v16, s[32:35], s48 offen sc1
    v_exp_f32 v108, v72
    ds_write2_b64 v10, v[116:117], v[118:119] offset1:16
    v_exp_f32 v109, v73
    v_mfma_f32_16x16x32_bf16 v[88:91], v[244:247], v[232:235], v[88:91]
    v_exp_f32 v110, v74
    v_exp_f32 v111, v75
    v_mfma_f32_16x16x32_bf16 v[88:91], v[248:251], v[236:239], v[88:91]
    v_exp_f32 v112, v76
    v_exp_f32 v113, v77
    v_exp_f32 v114, v78
    v_exp_f32 v115, v79
    v_pk_fma_f32 v[108:109], v[108:109], s[44:45], s[44:45]
    v_pk_fma_f32 v[110:111], v[110:111], s[44:45], s[44:45]
    v_pk_fma_f32 v[112:113], v[112:113], s[44:45], s[44:45]
    v_pk_fma_f32 v[114:115], v[114:115], s[44:45], s[44:45]
    v_rcp_f32 v108, v108
    v_rcp_f32 v109, v109
    v_rcp_f32 v110, v110
    v_rcp_f32 v111, v111
    v_rcp_f32 v112, v112
    s_waitcnt lgkmcnt(0)
    s_barrier
    ds_read_b128 v[124:127], v15 offset:0
    v_rcp_f32 v113, v113
    v_rcp_f32 v114, v114
    v_rcp_f32 v115, v115
    v_pk_mul_f32 v[72:73], v[72:73], v[108:109]
    v_pk_mul_f32 v[74:75], v[74:75], v[110:111]
    v_pk_mul_f32 v[76:77], v[76:77], v[112:113]
    v_pk_mul_f32 v[78:79], v[78:79], v[114:115]
    v_cvt_pk_bf16_f32 v120, v72, v73
    v_cvt_pk_bf16_f32 v121, v74, v75
    v_cvt_pk_bf16_f32 v122, v76, v77
    v_cvt_pk_bf16_f32 v123, v78, v79
    v_pk_fma_f32 v[80:81], v[80:81], v[92:93], v[96:97]
    v_pk_fma_f32 v[82:83], v[82:83], v[94:95], v[98:99]
    v_pk_fma_f32 v[84:85], v[84:85], v[92:93], v[96:97]
    v_pk_fma_f32 v[86:87], v[86:87], v[94:95], v[98:99]
    s_waitcnt lgkmcnt(0)
    s_movk_i32 s48, 7168
    buffer_store_dwordx4 v[124:127], v16, s[32:35], s48 offen sc1
    v_exp_f32 v100, v80
    ds_write2_b64 v11, v[120:121], v[122:123] offset1:16
    v_exp_f32 v101, v81
    v_exp_f32 v102, v82
    v_exp_f32 v103, v83
    v_exp_f32 v104, v84
    v_exp_f32 v105, v85
    v_exp_f32 v106, v86
    v_exp_f32 v107, v87
    v_pk_fma_f32 v[100:101], v[100:101], s[44:45], s[44:45]
    v_pk_fma_f32 v[102:103], v[102:103], s[44:45], s[44:45]
    v_pk_fma_f32 v[104:105], v[104:105], s[44:45], s[44:45]
    v_pk_fma_f32 v[106:107], v[106:107], s[44:45], s[44:45]
    v_rcp_f32 v100, v100
    v_rcp_f32 v101, v101
    v_rcp_f32 v102, v102
    v_rcp_f32 v103, v103
    v_rcp_f32 v104, v104
    s_waitcnt lgkmcnt(0)
    s_barrier
    ds_read_b128 v[128:131], v15 offset:4352
    v_rcp_f32 v105, v105
    v_rcp_f32 v106, v106
    v_rcp_f32 v107, v107
    v_pk_mul_f32 v[80:81], v[80:81], v[100:101]
    v_pk_mul_f32 v[82:83], v[82:83], v[102:103]
    v_pk_mul_f32 v[84:85], v[84:85], v[104:105]
    v_pk_mul_f32 v[86:87], v[86:87], v[106:107]
    v_cvt_pk_bf16_f32 v116, v80, v81
    v_cvt_pk_bf16_f32 v117, v82, v83
    v_cvt_pk_bf16_f32 v118, v84, v85
    v_cvt_pk_bf16_f32 v119, v86, v87
    v_pk_fma_f32 v[88:89], v[88:89], v[92:93], v[96:97]
    v_pk_fma_f32 v[90:91], v[90:91], v[94:95], v[98:99]
    s_waitcnt lgkmcnt(0)
    s_movk_i32 s48, 8960
    buffer_store_dwordx4 v[128:131], v16, s[32:35], s48 offen sc1
    v_exp_f32 v108, v88
    ds_write2_b64 v10, v[116:117], v[118:119] offset1:16
    v_exp_f32 v109, v89
    v_exp_f32 v110, v90
    v_exp_f32 v111, v91
    v_pk_fma_f32 v[108:109], v[108:109], s[44:45], s[44:45]
    v_pk_fma_f32 v[110:111], v[110:111], s[44:45], s[44:45]
    v_rcp_f32 v108, v108
    v_rcp_f32 v109, v109
    v_rcp_f32 v110, v110
    s_waitcnt lgkmcnt(0)
    s_barrier
    ds_read_b128 v[124:127], v15 offset:0
    v_rcp_f32 v111, v111
    v_pk_mul_f32 v[88:89], v[88:89], v[108:109]
    v_pk_mul_f32 v[90:91], v[90:91], v[110:111]
    v_cvt_pk_bf16_f32 v120, v88, v89
    v_cvt_pk_bf16_f32 v121, v90, v91
    ds_write_b64 v11, v[120:121]
    s_waitcnt lgkmcnt(1)
    s_movk_i32 s48, 10752
    buffer_store_dwordx4 v[124:127], v16, s[32:35], s48 offen sc1
    s_waitcnt lgkmcnt(0)
    s_barrier
    ds_read_b128 v[128:131], v15 offset:4352
    s_waitcnt lgkmcnt(0)
    s_mov_b32 exec_lo, 0x00ff00ff
    s_mov_b32 exec_hi, 0x00ff00ff
    s_movk_i32 s48, 12544
    buffer_store_dwordx4 v[128:131], v16, s[32:35], s48 offen sc1
    s_endpgm
L_mainend:
L_sload:
    v_lshrrev_b32 v1, 3, v0
    v_and_b32 v2, 7, v0
    v_bfe_u32 v3, v0, 4, 1
    v_lshrrev_b32 v4, 5, v0
    v_lshlrev_b32 v4, 1, v4
    v_lshl_or_b32 v4, v3, 2, v4
    v_xor_b32 v4, v2, v4
    v_mul_u32_u24 v5, 896, v1
    v_mul_u32_u24 v6, 7168, v1
    v_lshl_add_u32 v6, v4, 4, v6
    s_and_b32 s36, s20, 1
    s_mul_i32 s44, s36, 57344
    s_add_u32 s44, s44, 896
    v_add_u32 v6, s44, v6
    s_lshr_b32 s44, s20, 1
    s_sub_u32 s44, 7, s44
    s_mul_i32 s64, s44, 896
    s_lshl_b32 s37, s20, 10
    s_movk_i32 s66, 1152
    s_sub_u32 s22, s18, 1
    s_mul_hi_i32 s67, s22, 896
    s_mul_i32 s22, s22, 896
    s_mov_b32 s26, 116480
    s_mov_b32 s27, 0x20000
    v_lshlrev_b32 v3, 1, v3
    v_xor_b32 v4, v2, v3
    v_lshl_add_u32 v7, v4, 4, v5
    s_lshl_b32 s38, s36, 6
    v_xor_b32 v7, s38, v7
    s_mul_i32 s44, s20, 7168
    v_add_u32 v20, s44, v7
    s_lshl_b32 s68, s19, 7
    s_sub_u32 s30, 1204224, s68
    s_mov_b32 s31, 0x20000
    v_lshl_add_u32 v18, v0, 4, s38
    s_cmp_lt_u32 s20, 2
    s_cselect_b32 s44, 0x60, 0
    v_xor_b32 v18, s44, v18
    s_cselect_b32 s44, 0, 0x80000000
    v_add_u32 v18, s44, v18
    s_cselect_b32 s47, 0, 16512
    s_add_u32 s38, s38, s47
    s_mov_b64 s[72:73], 15
    s_add_u32 s48, s37, 0
    s_sub_u32 s56, s64, 0
    s_add_u32 s49, s37, 4096
    s_sub_u32 s57, s64, 1792
    s_add_u32 s50, s37, 8192
    s_sub_u32 s58, s64, 3584
    s_add_u32 s51, s37, 12288
    s_sub_u32 s59, s64, 5376
    s_waitcnt lgkmcnt(0)
    s_add_u32 s24, s4, s22
    s_addc_u32 s25, s5, s67
    s_add_u32 s28, s6, s68
    s_addc_u32 s29, s7, 0
    s_add_u32 m0, s37, 93952
    s_mov_b32 s39, 0
    buffer_load_dwordx4 v20, s[28:31], s39 offen lds
    s_add_u32 m0, s37, 102144
    s_mov_b32 s39, 401408
    buffer_load_dwordx4 v20, s[28:31], s39 offen lds
    s_add_u32 m0, s37, 110336
    s_mov_b32 s39, 802816
    buffer_load_dwordx4 v20, s[28:31], s39 offen lds
    s_add_u32 m0, s48, s66
    s_nop 0
    buffer_load_dwordx4 v6, s[24:27], s56 offen lds
    s_add_u32 m0, s49, s66
    s_nop 0
    buffer_load_dwordx4 v6, s[24:27], s57 offen lds
    s_add_u32 m0, s50, s66
    s_nop 0
    buffer_load_dwordx4 v6, s[24:27], s58 offen lds
    s_add_u32 m0, s51, s66
    s_nop 0
    buffer_load_dwordx4 v6, s[24:27], s59 offen lds
    s_add_u32 m0, s38, 1024
    s_mov_b64 exec, s[72:73]
    buffer_load_dwordx4 v18, s[24:27], 0 offen lds
    s_mov_b64 exec, -1
    s_add_u32 m0, s37, 98048
    s_mov_b32 s39, 28672
    buffer_load_dwordx4 v20, s[28:31], s39 offen lds
    s_add_u32 m0, s37, 106240
    s_mov_b32 s39, 430080
    buffer_load_dwordx4 v20, s[28:31], s39 offen lds
    s_add_u32 m0, s37, 114432
    s_mov_b32 s39, 831488
    buffer_load_dwordx4 v20, s[28:31], s39 offen lds
    s_add_u32 m0, s48, 32000
    s_nop 0
    buffer_load_dwordx4 v6, s[24:27], s56 offen offset:128 lds
    s_add_u32 m0, s49, 32000
    s_nop 0
    buffer_load_dwordx4 v6, s[24:27], s57 offen offset:128 lds
    s_add_u32 m0, s50, 32000
    s_nop 0
    buffer_load_dwordx4 v6, s[24:27], s58 offen offset:128 lds
    s_add_u32 m0, s51, 32000
    s_nop 0
    buffer_load_dwordx4 v6, s[24:27], s59 offen offset:128 lds
    s_add_u32 m0, s38, 31872
    s_mov_b64 exec, s[72:73]
    buffer_load_dwordx4 v18, s[24:27], 0 offen offset:128 lds
    s_mov_b64 exec, -1
    s_waitcnt vmcnt(8)
    s_barrier
    s_add_u32 m0, s37, 118528
    s_mov_b32 s39, 57344
    buffer_load_dwordx4 v20, s[28:31], s39 offen lds
    s_add_u32 m0, s37, 126720
    s_mov_b32 s39, 458752
    buffer_load_dwordx4 v20, s[28:31], s39 offen lds
    s_add_u32 m0, s37, 134912
    s_mov_b32 s39, 860160
    buffer_load_dwordx4 v20, s[28:31], s39 offen lds
    s_add_u32 m0, s37, 122624
    s_mov_b32 s39, 86016
    buffer_load_dwordx4 v20, s[28:31], s39 offen lds
    s_add_u32 m0, s37, 130816
    s_mov_b32 s39, 487424
    buffer_load_dwordx4 v20, s[28:31], s39 offen lds
    s_add_u32 m0, s37, 139008
    s_mov_b32 s39, 888832
    buffer_load_dwordx4 v20, s[28:31], s39 offen lds
    s_waitcnt vmcnt(11)
    s_barrier
    s_add_u32 m0, s48, 62848
    s_nop 0
    buffer_load_dwordx4 v6, s[24:27], s56 offen offset:256 lds
    s_add_u32 m0, s49, 62848
    s_nop 0
    buffer_load_dwordx4 v6, s[24:27], s57 offen offset:256 lds
    s_add_u32 m0, s50, 62848
    s_nop 0
    buffer_load_dwordx4 v6, s[24:27], s58 offen offset:256 lds
    s_add_u32 m0, s51, 62848
    s_nop 0
    buffer_load_dwordx4 v6, s[24:27], s59 offen offset:256 lds
    s_add_u32 m0, s38, 62720
    s_mov_b64 exec, s[72:73]
    buffer_load_dwordx4 v18, s[24:27], 0 offen offset:256 lds
    s_mov_b64 exec, -1
    s_add_u32 m0, s37, 93952
    s_mov_b32 s39, 114688
    buffer_load_dwordx4 v20, s[28:31], s39 offen lds
    s_add_u32 m0, s37, 102144
    s_mov_b32 s39, 516096
    buffer_load_dwordx4 v20, s[28:31], s39 offen lds
    s_add_u32 m0, s37, 110336
    s_mov_b32 s39, 917504
    buffer_load_dwordx4 v20, s[28:31], s39 offen lds
    s_waitcnt vmcnt(11)
    s_barrier
    s_add_u32 m0, s37, 98048
    s_mov_b32 s39, 143360
    buffer_load_dwordx4 v20, s[28:31], s39 offen lds
    s_add_u32 m0, s37, 106240
    s_mov_b32 s39, 544768
    buffer_load_dwordx4 v20, s[28:31], s39 offen lds
    s_add_u32 m0, s37, 114432
    s_mov_b32 s39, 946176
    buffer_load_dwordx4 v20, s[28:31], s39 offen lds
    s_add_u32 m0, s48, 768
    s_nop 0
    buffer_load_dwordx4 v6, s[24:27], s56 offen offset:384 lds
    s_add_u32 m0, s49, 768
    s_nop 0
    buffer_load_dwordx4 v6, s[24:27], s57 offen offset:384 lds
    s_add_u32 m0, s50, 768
    s_nop 0
    buffer_load_dwordx4 v6, s[24:27], s58 offen offset:384 lds
    s_add_u32 m0, s51, 768
    s_nop 0
    buffer_load_dwordx4 v6, s[24:27], s59 offen offset:384 lds
    s_add_u32 m0, s38, 640
    s_mov_b64 exec, s[72:73]
    buffer_load_dwordx4 v18, s[24:27], 0 offen offset:384 lds
    s_mov_b64 exec, -1
    s_waitcnt vmcnt(16)
    s_barrier
    s_add_u32 m0, s37, 118528
    s_mov_b32 s39, 172032
    buffer_load_dwordx4 v20, s[28:31], s39 offen lds
    s_add_u32 m0, s37, 126720
    s_mov_b32 s39, 573440
    buffer_load_dwordx4 v20, s[28:31], s39 offen lds
    s_add_u32 m0, s37, 134912
    s_mov_b32 s39, 974848
    buffer_load_dwordx4 v20, s[28:31], s39 offen lds
    s_waitcnt vmcnt(11)
    s_barrier
    s_add_u32 m0, s37, 122624
    s_mov_b32 s39, 200704
    buffer_load_dwordx4 v20, s[28:31], s39 offen lds
    s_add_u32 m0, s37, 130816
    s_mov_b32 s39, 602112
    buffer_load_dwordx4 v20, s[28:31], s39 offen lds
    s_add_u32 m0, s37, 139008
    s_mov_b32 s39, 1003520
    buffer_load_dwordx4 v20, s[28:31], s39 offen lds
    s_add_u32 m0, s48, 31616
    s_nop 0
    buffer_load_dwordx4 v6, s[24:27], s56 offen offset:512 lds
    s_add_u32 m0, s49, 31616
    s_nop 0
    buffer_load_dwordx4 v6, s[24:27], s57 offen offset:512 lds
    s_add_u32 m0, s50, 31616
    s_nop 0
    buffer_load_dwordx4 v6, s[24:27], s58 offen offset:512 lds
    s_add_u32 m0, s51, 31616
    s_nop 0
    buffer_load_dwordx4 v6, s[24:27], s59 offen offset:512 lds
    s_add_u32 m0, s38, 31488
    s_mov_b64 exec, s[72:73]
    buffer_load_dwordx4 v18, s[24:27], 0 offen offset:512 lds
    s_mov_b64 exec, -1
    s_waitcnt vmcnt(16)
    s_barrier
    s_add_u32 m0, s37, 93952
    s_mov_b32 s39, 229376
    buffer_load_dwordx4 v20, s[28:31], s39 offen lds
    s_add_u32 m0, s37, 102144
    s_mov_b32 s39, 630784
    buffer_load_dwordx4 v20, s[28:31], s39 offen lds
    s_add_u32 m0, s37, 110336
    s_mov_b32 s39, 1032192
    buffer_load_dwordx4 v20, s[28:31], s39 offen lds
    s_waitcnt vmcnt(11)
    s_barrier
    s_add_u32 m0, s37, 98048
    s_mov_b32 s39, 258048
    buffer_load_dwordx4 v20, s[28:31], s39 offen lds
    s_add_u32 m0, s37, 106240
    s_mov_b32 s39, 659456
    buffer_load_dwordx4 v20, s[28:31], s39 offen lds
    s_add_u32 m0, s37, 114432
    s_mov_b32 s39, 1060864
    buffer_load_dwordx4 v20, s[28:31], s39 offen lds
    s_add_u32 m0, s48, 62464
    s_nop 0
    buffer_load_dwordx4 v6, s[24:27], s56 offen offset:640 lds
    s_add_u32 m0, s49, 62464
    s_nop 0
    buffer_load_dwordx4 v6, s[24:27], s57 offen offset:640 lds
    s_add_u32 m0, s50, 62464
    s_nop 0
    buffer_load_dwordx4 v6, s[24:27], s58 offen offset:640 lds
    s_add_u32 m0, s51, 62464
    s_nop 0
    buffer_load_dwordx4 v6, s[24:27], s59 offen offset:640 lds
    s_add_u32 m0, s38, 62336
    s_mov_b64 exec, s[72:73]
    buffer_load_dwordx4 v18, s[24:27], 0 offen offset:640 lds
    s_mov_b64 exec, -1
    s_load_dwordx8 s[8:15], s[0:1], 16
    s_waitcnt vmcnt(16)
    s_barrier
    s_add_u32 m0, s37, 118528
    s_mov_b32 s39, 286720
    buffer_load_dwordx4 v20, s[28:31], s39 offen lds
    s_add_u32 m0, s37, 126720
    s_mov_b32 s39, 688128
    buffer_load_dwordx4 v20, s[28:31], s39 offen lds
    s_add_u32 m0, s37, 134912
    s_mov_b32 s39, 1089536
    buffer_load_dwordx4 v20, s[28:31], s39 offen lds
    s_waitcnt vmcnt(11)
    s_barrier
    s_add_u32 m0, s37, 122624
    s_mov_b32 s39, 315392
    buffer_load_dwordx4 v20, s[28:31], s39 offen lds
    s_add_u32 m0, s37, 130816
    s_mov_b32 s39, 716800
    buffer_load_dwordx4 v20, s[28:31], s39 offen lds
    s_add_u32 m0, s37, 139008
    s_mov_b32 s39, 1118208
    buffer_load_dwordx4 v20, s[28:31], s39 offen lds
    s_add_u32 m0, s48, 384
    s_nop 0
    buffer_load_dwordx4 v6, s[24:27], s56 offen offset:768 lds
    s_add_u32 m0, s49, 384
    s_nop 0
    buffer_load_dwordx4 v6, s[24:27], s57 offen offset:768 lds
    s_add_u32 m0, s50, 384
    s_nop 0
    buffer_load_dwordx4 v6, s[24:27], s58 offen offset:768 lds
    s_add_u32 m0, s51, 384
    s_nop 0
    buffer_load_dwordx4 v6, s[24:27], s59 offen offset:768 lds
    s_add_u32 m0, s38, 256
    s_mov_b64 exec, s[72:73]
    buffer_load_dwordx4 v18, s[24:27], 0 offen offset:768 lds
    s_mov_b64 exec, -1
    s_waitcnt vmcnt(16)
    s_barrier
    s_add_u32 m0, s37, 93952
    s_mov_b32 s39, 344064
    buffer_load_dwordx4 v20, s[28:31], s39 offen lds
    s_add_u32 m0, s37, 102144
    s_mov_b32 s39, 745472
    buffer_load_dwordx4 v20, s[28:31], s39 offen lds
    s_add_u32 m0, s37, 110336
    s_mov_b32 s39, 1146880
    buffer_load_dwordx4 v20, s[28:31], s39 offen lds
    s_waitcnt vmcnt(11)
    s_barrier
    s_add_u32 m0, s37, 98048
    s_mov_b32 s39, 372736
    buffer_load_dwordx4 v20, s[28:31], s39 offen lds
    s_add_u32 m0, s37, 106240
    s_mov_b32 s39, 774144
    buffer_load_dwordx4 v20, s[28:31], s39 offen lds
    s_add_u32 m0, s37, 114432
    s_mov_b32 s39, 1175552
    buffer_load_dwordx4 v20, s[28:31], s39 offen lds
    v_lshl_add_u32 v1, v0, 1, s68
    s_waitcnt lgkmcnt(0)
    global_load_ushort v32, v1, s[8:9]
    global_load_ushort v33, v1, s[10:11]
    global_load_ushort v34, v1, s[12:13]
    global_load_ushort v35, v1, s[14:15]
    s_waitcnt vmcnt(15)
    s_barrier
    s_waitcnt vmcnt(7)
    s_barrier
    s_setprio 2
    s_waitcnt vmcnt(0)
    v_lshlrev_b32 v32, 16, v32
    v_lshlrev_b32 v33, 16, v33
    v_lshlrev_b32 v34, 16, v34
    v_lshlrev_b32 v35, 16, v35
    v_add_f32 v33, 0x3727c5ac, v33
    v_cvt_pk_bf16_f32 v33, v33, v33
    v_lshlrev_b32 v33, 16, v33
    v_sqrt_f32 v33, v33
    s_nop 0
    v_cvt_pk_bf16_f32 v33, v33, v33
    v_lshlrev_b32 v33, 16, v33
    v_rcp_f32 v33, v33
    s_nop 0
    v_cvt_pk_bf16_f32 v33, v33, v33
    v_lshlrev_b32 v33, 16, v33
    v_mul_f32 v33, v34, v33
    v_cvt_pk_bf16_f32 v33, v33, v33
    v_lshlrev_b32 v33, 16, v33
    v_fma_f32 v35, -v32, v33, v35
    v_mul_f32 v33, 0xbfb8aa3b, v33
    v_mul_f32 v35, 0xbfb8aa3b, v35
    v_lshlrev_b32 v1, 2, v0
    ds_write_b32 v1, v33
    ds_write_b32 v1, v35 offset:256
    s_waitcnt lgkmcnt(0)
    s_waitcnt vmcnt(4)
    s_barrier
    s_endpgm
L_hc2:
    s_cmp_eq_u32 s19, 7
    s_cbranch_scc1 L_end
    s_load_dwordx2 s[16:17], s[0:1], 48
    s_sub_u32 s21, s20, 4
    v_and_b32 v6, 15, v0
    v_lshrrev_b32 v7, 4, v0
    v_add_u32 v8, -1, v6
    v_bfe_u32 v10, v8, 1, 1
    v_bfe_u32 v8, v8, 2, 1
    v_lshlrev_b32 v8, 1, v8
    v_lshl_or_b32 v8, v10, 2, v8
    v_xor_b32 v8, v8, v7
    v_lshlrev_b32 v8, 4, v8
    v_lshl_add_u32 v20, v6, 7, v8
    v_add_u32 v20, 1024, v20
    v_xor_b32 v21, 64, v20
    v_mov_b32 v8, v6
    v_bfe_u32 v10, v8, 1, 1
    v_bfe_u32 v8, v8, 2, 1
    v_lshlrev_b32 v8, 1, v8
    v_lshl_or_b32 v8, v10, 2, v8
    v_xor_b32 v8, v8, v7
    v_lshlrev_b32 v8, 4, v8
    v_lshl_add_u32 v22, v6, 7, v8
    v_add_u32 v22, 1152, v22
    v_xor_b32 v23, 64, v22
    v_add_u32 v8, 1, v6
    v_bfe_u32 v10, v8, 1, 1
    v_bfe_u32 v8, v8, 2, 1
    v_lshlrev_b32 v8, 1, v8
    v_lshl_or_b32 v8, v10, 2, v8
    v_xor_b32 v8, v8, v7
    v_lshlrev_b32 v8, 4, v8
    v_lshl_add_u32 v24, v6, 7, v8
    v_add_u32 v24, 1280, v24
    v_xor_b32 v25, 64, v24
    v_bfe_u32 v8, v0, 2, 2
    v_lshl_add_u32 v9, v7, 3, v8
    v_lshlrev_b32 v9, 7, v9
    v_bfe_u32 v10, v0, 3, 2
    v_xor_b32 v10, s21, v10
    v_lshl_add_u32 v9, v10, 5, v9
    v_and_b32 v10, 3, v0
    v_lshl_add_u32 v9, v10, 3, v9
    v_add_u32 v26, 93952, v9
    v_mov_b64 v[32:33], 0
    v_mov_b64 v[34:35], 0
    v_mov_b64 v[36:37], 0
    v_mov_b64 v[38:39], 0
    v_mov_b64 v[40:41], 0
    v_mov_b64 v[42:43], 0
    v_mov_b64 v[44:45], 0
    v_mov_b64 v[46:47], 0
    v_mov_b64 v[48:49], 0
    v_mov_b64 v[50:51], 0
    v_mov_b64 v[52:53], 0
    v_mov_b64 v[54:55], 0
    v_mov_b64 v[56:57], 0
    v_mov_b64 v[58:59], 0
    v_mov_b64 v[60:61], 0
    v_mov_b64 v[62:63], 0
    s_lshl_b32 s22, s21, 5
    s_add_u32 s22, s22, 143104
    v_mul_u32_u24 v9, 272, v6
    v_lshl_add_u32 v9, v7, 3, v9
    v_add_u32 v10, s22, v9
    s_lshl_b32 s22, s21, 2
    v_add_u32 v14, s22, v7
    v_mul_u32_u24 v15, 272, v14
    v_lshl_add_u32 v15, v6, 4, v15
    v_add_u32 v15, 143104, v15
    v_bfe_u32 v8, v0, 3, 1
    v_mad_u32_u24 v16, v14, 8, v8
    v_mul_u32_u24 v16, 896, v16
    v_and_b32 v8, 7, v0
    v_lshl_add_u32 v16, v8, 4, v16
    v_lshlrev_b32 v17, 4, v14
    s_mul_i32 s22, s18, 896
    s_lshl_b32 s23, s19, 7
    s_add_u32 s22, s22, s23
    s_sub_u32 s34, 114688, s23
    s_mov_b32 s35, 0x20000
    s_mov_b32 s40, 0
    s_mov_b32 s41, 30976
    s_mov_b32 s42, 24576
    s_mov_b32 s44, 0xbfb8aa3b
    s_mov_b32 s45, 0xbfb8aa3b
    s_mov_b32 s46, 30976
    s_mov_b32 s47, 4294905344
    s_waitcnt lgkmcnt(0)
    s_add_u32 s32, s16, s22
    s_addc_u32 s33, s17, 0
    s_branch S_pg2
    .p2align 12
S_pg2:
    s_setprio 1
    s_barrier
    ds_read_b64_tr_b16 v[132:133], v26 offset:0
    ds_read_b64_tr_b16 v[134:135], v26 offset:512
    ds_read_b64_tr_b16 v[136:137], v26 offset:8192
    ds_read_b64_tr_b16 v[138:139], v26 offset:8704
    ds_read_b64_tr_b16 v[140:141], v26 offset:16384
    ds_read_b64_tr_b16 v[142:143], v26 offset:16896
    ds_read_b128 v[92:95], v20 offset:0
    ds_read_b128 v[96:99], v22 offset:14336
    ds_read_b128 v[100:103], v22 offset:12288
    ds_read_b128 v[104:107], v22 offset:10240
    ds_read_b128 v[108:111], v22 offset:8192
    ds_read_b128 v[112:115], v22 offset:6144
    ds_read_b128 v[116:119], v22 offset:4096
    ds_read_b128 v[120:123], v22 offset:2048
    ds_read_b128 v[124:127], v22 offset:0
    ds_read_b128 v[128:131], v24 offset:14336
S_loop:
    s_waitcnt lgkmcnt(0)
    v_mfma_f32_16x16x32_bf16 v[32:35], v[132:135], v[92:95], v[32:35]
    v_add_u32 v20, s41, v20
    v_mfma_f32_16x16x32_bf16 v[32:35], v[136:139], v[96:99], v[32:35]
    v_add_u32 v22, s41, v22
    v_mfma_f32_16x16x32_bf16 v[32:35], v[140:143], v[100:103], v[32:35]
    v_add_u32 v24, s41, v24
    v_mfma_f32_16x16x32_bf16 v[36:39], v[140:143], v[104:107], v[36:39]
    s_add_u32 s40, s40, 1
    v_mfma_f32_16x16x32_bf16 v[36:39], v[136:139], v[100:103], v[36:39]
    s_barrier
    v_mfma_f32_16x16x32_bf16 v[36:39], v[132:135], v[96:99], v[36:39]
    ds_read_b64_tr_b16 v[184:185], v26 offset:4096
    v_mfma_f32_16x16x32_bf16 v[40:43], v[132:135], v[100:103], v[40:43]
    ds_read_b64_tr_b16 v[186:187], v26 offset:4608
    v_mfma_f32_16x16x32_bf16 v[40:43], v[136:139], v[104:107], v[40:43]
    ds_read_b64_tr_b16 v[188:189], v26 offset:12288
    v_mfma_f32_16x16x32_bf16 v[40:43], v[140:143], v[108:111], v[40:43]
    ds_read_b64_tr_b16 v[190:191], v26 offset:12800
    v_mfma_f32_16x16x32_bf16 v[44:47], v[140:143], v[112:115], v[44:47]
    ds_read_b64_tr_b16 v[192:193], v26 offset:20480
    v_mfma_f32_16x16x32_bf16 v[44:47], v[136:139], v[108:111], v[44:47]
    ds_read_b64_tr_b16 v[194:195], v26 offset:20992
    v_mfma_f32_16x16x32_bf16 v[44:47], v[132:135], v[104:107], v[44:47]
    ds_read_b128 v[144:147], v21 offset:0
    v_mfma_f32_16x16x32_bf16 v[48:51], v[132:135], v[108:111], v[48:51]
    ds_read_b128 v[148:151], v23 offset:14336
    v_mfma_f32_16x16x32_bf16 v[48:51], v[136:139], v[112:115], v[48:51]
    ds_read_b128 v[152:155], v23 offset:12288
    v_mfma_f32_16x16x32_bf16 v[48:51], v[140:143], v[116:119], v[48:51]
    ds_read_b128 v[156:159], v23 offset:10240
    v_mfma_f32_16x16x32_bf16 v[52:55], v[140:143], v[120:123], v[52:55]
    ds_read_b128 v[160:163], v23 offset:8192
    v_mfma_f32_16x16x32_bf16 v[52:55], v[136:139], v[116:119], v[52:55]
    ds_read_b128 v[164:167], v23 offset:6144
    v_mfma_f32_16x16x32_bf16 v[52:55], v[132:135], v[112:115], v[52:55]
    ds_read_b128 v[168:171], v23 offset:4096
    v_mfma_f32_16x16x32_bf16 v[56:59], v[132:135], v[116:119], v[56:59]
    ds_read_b128 v[172:175], v23 offset:2048
    v_mfma_f32_16x16x32_bf16 v[56:59], v[136:139], v[120:123], v[56:59]
    ds_read_b128 v[176:179], v23 offset:0
    v_mfma_f32_16x16x32_bf16 v[56:59], v[140:143], v[124:127], v[56:59]
    ds_read_b128 v[180:183], v25 offset:14336
    v_mfma_f32_16x16x32_bf16 v[60:63], v[140:143], v[128:131], v[60:63]
    v_mfma_f32_16x16x32_bf16 v[60:63], v[136:139], v[124:127], v[60:63]
    s_cmp_lt_u32 s40, 7
    v_mfma_f32_16x16x32_bf16 v[60:63], v[132:135], v[120:123], v[60:63]
    s_cbranch_scc0 S_tail
    s_waitcnt lgkmcnt(0)
    v_mfma_f32_16x16x32_bf16 v[32:35], v[184:187], v[144:147], v[32:35]
    v_add_u32 v21, s41, v21
    v_mfma_f32_16x16x32_bf16 v[32:35], v[188:191], v[148:151], v[32:35]
    v_add_u32 v23, s41, v23
    v_mfma_f32_16x16x32_bf16 v[32:35], v[192:195], v[152:155], v[32:35]
    v_add_u32 v25, s41, v25
    v_mfma_f32_16x16x32_bf16 v[36:39], v[192:195], v[156:159], v[36:39]
    v_add_u32 v26, s42, v26
    v_mfma_f32_16x16x32_bf16 v[36:39], v[188:191], v[152:155], v[36:39]
    s_barrier
    s_sub_u32 s42, 0, s42
    v_mfma_f32_16x16x32_bf16 v[36:39], v[184:187], v[148:151], v[36:39]
    ds_read_b64_tr_b16 v[132:133], v26 offset:0
    v_mfma_f32_16x16x32_bf16 v[40:43], v[184:187], v[152:155], v[40:43]
    ds_read_b64_tr_b16 v[134:135], v26 offset:512
    v_mfma_f32_16x16x32_bf16 v[40:43], v[188:191], v[156:159], v[40:43]
    ds_read_b64_tr_b16 v[136:137], v26 offset:8192
    v_mfma_f32_16x16x32_bf16 v[40:43], v[192:195], v[160:163], v[40:43]
    ds_read_b64_tr_b16 v[138:139], v26 offset:8704
    v_mfma_f32_16x16x32_bf16 v[44:47], v[192:195], v[164:167], v[44:47]
    ds_read_b64_tr_b16 v[140:141], v26 offset:16384
    v_mfma_f32_16x16x32_bf16 v[44:47], v[188:191], v[160:163], v[44:47]
    ds_read_b64_tr_b16 v[142:143], v26 offset:16896
    v_mfma_f32_16x16x32_bf16 v[44:47], v[184:187], v[156:159], v[44:47]
    ds_read_b128 v[92:95], v20 offset:0
    v_mfma_f32_16x16x32_bf16 v[48:51], v[184:187], v[160:163], v[48:51]
    ds_read_b128 v[96:99], v22 offset:14336
    v_mfma_f32_16x16x32_bf16 v[48:51], v[188:191], v[164:167], v[48:51]
    ds_read_b128 v[100:103], v22 offset:12288
    v_mfma_f32_16x16x32_bf16 v[48:51], v[192:195], v[168:171], v[48:51]
    ds_read_b128 v[104:107], v22 offset:10240
    v_mfma_f32_16x16x32_bf16 v[52:55], v[192:195], v[172:175], v[52:55]
    ds_read_b128 v[108:111], v22 offset:8192
    v_mfma_f32_16x16x32_bf16 v[52:55], v[188:191], v[168:171], v[52:55]
    ds_read_b128 v[112:115], v22 offset:6144
    v_mfma_f32_16x16x32_bf16 v[52:55], v[184:187], v[164:167], v[52:55]
    ds_read_b128 v[116:119], v22 offset:4096
    v_mfma_f32_16x16x32_bf16 v[56:59], v[184:187], v[168:171], v[56:59]
    ds_read_b128 v[120:123], v22 offset:2048
    v_mfma_f32_16x16x32_bf16 v[56:59], v[188:191], v[172:175], v[56:59]
    ds_read_b128 v[124:127], v22 offset:0
    v_mfma_f32_16x16x32_bf16 v[56:59], v[192:195], v[176:179], v[56:59]
    ds_read_b128 v[128:131], v24 offset:14336
    v_mfma_f32_16x16x32_bf16 v[60:63], v[192:195], v[180:183], v[60:63]
    s_cmp_eq_u32 s40, 2
    s_cselect_b32 s43, 5, s40
    v_mfma_f32_16x16x32_bf16 v[60:63], v[188:191], v[176:179], v[60:63]
    s_cmp_eq_u32 s43, 5
    s_cselect_b32 s41, s47, s46
    v_mfma_f32_16x16x32_bf16 v[60:63], v[184:187], v[172:175], v[60:63]
    s_branch S_loop
S_tail:
    s_waitcnt lgkmcnt(0)
    v_mfma_f32_16x16x32_bf16 v[32:35], v[184:187], v[144:147], v[32:35]
    ds_read_b128 v[92:95], v17
    v_mfma_f32_16x16x32_bf16 v[32:35], v[188:191], v[148:151], v[32:35]
    ds_read_b128 v[96:99], v17 offset:256
    v_add_u32 v11, 4352, v10
    v_mfma_f32_16x16x32_bf16 v[32:35], v[192:195], v[152:155], v[32:35]
    v_mfma_f32_16x16x32_bf16 v[36:39], v[192:195], v[156:159], v[36:39]
    v_mfma_f32_16x16x32_bf16 v[36:39], v[188:191], v[152:155], v[36:39]
    v_mfma_f32_16x16x32_bf16 v[36:39], v[184:187], v[148:151], v[36:39]
    v_mfma_f32_16x16x32_bf16 v[40:43], v[184:187], v[152:155], v[40:43]
    v_mfma_f32_16x16x32_bf16 v[40:43], v[188:191], v[156:159], v[40:43]
    v_mfma_f32_16x16x32_bf16 v[40:43], v[192:195], v[160:163], v[40:43]
    v_mfma_f32_16x16x32_bf16 v[44:47], v[192:195], v[164:167], v[44:47]
    v_mfma_f32_16x16x32_bf16 v[44:47], v[188:191], v[160:163], v[44:47]
    v_mfma_f32_16x16x32_bf16 v[44:47], v[184:187], v[156:159], v[44:47]
    s_waitcnt lgkmcnt(0)
    v_pk_fma_f32 v[32:33], v[32:33], v[92:93], v[96:97]
    v_pk_fma_f32 v[34:35], v[34:35], v[94:95], v[98:99]
    v_pk_fma_f32 v[36:37], v[36:37], v[92:93], v[96:97]
    v_pk_fma_f32 v[38:39], v[38:39], v[94:95], v[98:99]
    v_mfma_f32_16x16x32_bf16 v[48:51], v[184:187], v[160:163], v[48:51]
    v_exp_f32 v100, v32
    v_exp_f32 v101, v33
    v_mfma_f32_16x16x32_bf16 v[48:51], v[188:191], v[164:167], v[48:51]
    v_exp_f32 v102, v34
    v_exp_f32 v103, v35
    v_mfma_f32_16x16x32_bf16 v[48:51], v[192:195], v[168:171], v[48:51]
    v_exp_f32 v104, v36
    v_exp_f32 v105, v37
    v_exp_f32 v106, v38
    v_exp_f32 v107, v39
    v_pk_fma_f32 v[100:101], v[100:101], s[44:45], s[44:45]
    v_pk_fma_f32 v[102:103], v[102:103], s[44:45], s[44:45]
    v_pk_fma_f32 v[104:105], v[104:105], s[44:45], s[44:45]
    v_pk_fma_f32 v[106:107], v[106:107], s[44:45], s[44:45]
    v_mfma_f32_16x16x32_bf16 v[52:55], v[192:195], v[172:175], v[52:55]
    v_rcp_f32 v100, v100
    v_rcp_f32 v101, v101
    v_mfma_f32_16x16x32_bf16 v[52:55], v[188:191], v[168:171], v[52:55]
    v_rcp_f32 v102, v102
    v_rcp_f32 v103, v103
    v_mfma_f32_16x16x32_bf16 v[52:55], v[184:187], v[164:167], v[52:55]
    v_rcp_f32 v104, v104
    v_rcp_f32 v105, v105
    v_rcp_f32 v106, v106
    v_rcp_f32 v107, v107
    v_pk_mul_f32 v[32:33], v[32:33], v[100:101]
    v_pk_mul_f32 v[34:35], v[34:35], v[102:103]
    v_pk_mul_f32 v[36:37], v[36:37], v[104:105]
    v_pk_mul_f32 v[38:39], v[38:39], v[106:107]
    v_cvt_pk_bf16_f32 v116, v32, v33
    v_cvt_pk_bf16_f32 v117, v34, v35
    v_cvt_pk_bf16_f32 v118, v36, v37
    v_cvt_pk_bf16_f32 v119, v38, v39
    v_pk_fma_f32 v[40:41], v[40:41], v[92:93], v[96:97]
    v_pk_fma_f32 v[42:43], v[42:43], v[94:95], v[98:99]
    v_pk_fma_f32 v[44:45], v[44:45], v[92:93], v[96:97]
    v_pk_fma_f32 v[46:47], v[46:47], v[94:95], v[98:99]
    v_mfma_f32_16x16x32_bf16 v[56:59], v[184:187], v[168:171], v[56:59]
    v_exp_f32 v108, v40
    ds_write2_b64 v10, v[116:117], v[118:119] offset1:16
    v_exp_f32 v109, v41
    v_mfma_f32_16x16x32_bf16 v[56:59], v[188:191], v[172:175], v[56:59]
    v_exp_f32 v110, v42
    v_exp_f32 v111, v43
    v_mfma_f32_16x16x32_bf16 v[56:59], v[192:195], v[176:179], v[56:59]
    v_exp_f32 v112, v44
    v_exp_f32 v113, v45
    v_exp_f32 v114, v46
    v_exp_f32 v115, v47
    v_pk_fma_f32 v[108:109], v[108:109], s[44:45], s[44:45]
    v_pk_fma_f32 v[110:111], v[110:111], s[44:45], s[44:45]
    v_pk_fma_f32 v[112:113], v[112:113], s[44:45], s[44:45]
    v_pk_fma_f32 v[114:115], v[114:115], s[44:45], s[44:45]
    v_mfma_f32_16x16x32_bf16 v[60:63], v[192:195], v[180:183], v[60:63]
    v_rcp_f32 v108, v108
    v_rcp_f32 v109, v109
    v_mfma_f32_16x16x32_bf16 v[60:63], v[188:191], v[176:179], v[60:63]
    v_rcp_f32 v110, v110
    v_rcp_f32 v111, v111
    v_mfma_f32_16x16x32_bf16 v[60:63], v[184:187], v[172:175], v[60:63]
    v_rcp_f32 v112, v112
    s_waitcnt lgkmcnt(0)
    s_barrier
    ds_read_b128 v[124:127], v15 offset:0
    v_rcp_f32 v113, v113
    v_rcp_f32 v114, v114
    v_rcp_f32 v115, v115
    v_pk_mul_f32 v[40:41], v[40:41], v[108:109]
    v_pk_mul_f32 v[42:43], v[42:43], v[110:111]
    v_pk_mul_f32 v[44:45], v[44:45], v[112:113]
    v_pk_mul_f32 v[46:47], v[46:47], v[114:115]
    v_cvt_pk_bf16_f32 v120, v40, v41
    v_cvt_pk_bf16_f32 v121, v42, v43
    v_cvt_pk_bf16_f32 v122, v44, v45
    v_cvt_pk_bf16_f32 v123, v46, v47
    v_pk_fma_f32 v[48:49], v[48:49], v[92:93], v[96:97]
    v_pk_fma_f32 v[50:51], v[50:51], v[94:95], v[98:99]
    v_pk_fma_f32 v[52:53], v[52:53], v[92:93], v[96:97]
    v_pk_fma_f32 v[54:55], v[54:55], v[94:95], v[98:99]
    s_waitcnt lgkmcnt(0)
    s_movk_i32 s48, 0
    buffer_store_dwordx4 v[124:127], v16, s[32:35], s48 offen sc1
    v_exp_f32 v100, v48
    ds_write2_b64 v11, v[120:121], v[122:123] offset1:16
    v_exp_f32 v101, v49
    v_exp_f32 v102, v50
    v_exp_f32 v103, v51
    v_exp_f32 v104, v52
    v_exp_f32 v105, v53
    v_exp_f32 v106, v54
    v_exp_f32 v107, v55
    v_pk_fma_f32 v[100:101], v[100:101], s[44:45], s[44:45]
    v_pk_fma_f32 v[102:103], v[102:103], s[44:45], s[44:45]
    v_pk_fma_f32 v[104:105], v[104:105], s[44:45], s[44:45]
    v_pk_fma_f32 v[106:107], v[106:107], s[44:45], s[44:45]
    v_rcp_f32 v100, v100
    v_rcp_f32 v101, v101
    v_rcp_f32 v102, v102
    v_rcp_f32 v103, v103
    v_rcp_f32 v104, v104
    s_waitcnt lgkmcnt(0)
    s_barrier
    ds_read_b128 v[128:131], v15 offset:4352
    v_rcp_f32 v105, v105
    v_rcp_f32 v106, v106
    v_rcp_f32 v107, v107
    v_pk_mul_f32 v[48:49], v[48:49], v[100:101]
    v_pk_mul_f32 v[50:51], v[50:51], v[102:103]
    v_pk_mul_f32 v[52:53], v[52:53], v[104:105]
    v_pk_mul_f32 v[54:55], v[54:55], v[106:107]
    v_cvt_pk_bf16_f32 v116, v48, v49
    v_cvt_pk_bf16_f32 v117, v50, v51
    v_cvt_pk_bf16_f32 v118, v52, v53
    v_cvt_pk_bf16_f32 v119, v54, v55
    v_pk_fma_f32 v[56:57], v[56:57], v[92:93], v[96:97]
    v_pk_fma_f32 v[58:59], v[58:59], v[94:95], v[98:99]
    v_pk_fma_f32 v[60:61], v[60:61], v[92:93], v[96:97]
    v_pk_fma_f32 v[62:63], v[62:63], v[94:95], v[98:99]
    s_waitcnt lgkmcnt(0)
    s_movk_i32 s48, 1792
    buffer_store_dwordx4 v[128:131], v16, s[32:35], s48 offen sc1
    v_exp_f32 v108, v56
    ds_write2_b64 v10, v[116:117], v[118:119] offset1:16
    v_exp_f32 v109, v57
    v_exp_f32 v110, v58
    v_exp_f32 v111, v59
    v_exp_f32 v112, v60
    v_exp_f32 v113, v61
    v_exp_f32 v114, v62
    v_exp_f32 v115, v63
    v_pk_fma_f32 v[108:109], v[108:109], s[44:45], s[44:45]
    v_pk_fma_f32 v[110:111], v[110:111], s[44:45], s[44:45]
    v_pk_fma_f32 v[112:113], v[112:113], s[44:45], s[44:45]
    v_pk_fma_f32 v[114:115], v[114:115], s[44:45], s[44:45]
    v_rcp_f32 v108, v108
    v_rcp_f32 v109, v109
    v_rcp_f32 v110, v110
    v_rcp_f32 v111, v111
    v_rcp_f32 v112, v112
    s_waitcnt lgkmcnt(0)
    s_barrier
    ds_read_b128 v[124:127], v15 offset:0
    v_rcp_f32 v113, v113
    v_rcp_f32 v114, v114
    v_rcp_f32 v115, v115
    v_pk_mul_f32 v[56:57], v[56:57], v[108:109]
    v_pk_mul_f32 v[58:59], v[58:59], v[110:111]
    v_pk_mul_f32 v[60:61], v[60:61], v[112:113]
    v_pk_mul_f32 v[62:63], v[62:63], v[114:115]
    v_cvt_pk_bf16_f32 v120, v56, v57
    v_cvt_pk_bf16_f32 v121, v58, v59
    v_cvt_pk_bf16_f32 v122, v60, v61
    v_cvt_pk_bf16_f32 v123, v62, v63
    ds_write2_b64 v11, v[120:121], v[122:123] offset1:16
    s_waitcnt lgkmcnt(1)
    s_movk_i32 s48, 3584
    buffer_store_dwordx4 v[124:127], v16, s[32:35], s48 offen sc1
    s_waitcnt lgkmcnt(0)
    s_barrier
    ds_read_b128 v[128:131], v15 offset:4352
    s_waitcnt lgkmcnt(0)
    s_movk_i32 s48, 5376
    buffer_store_dwordx4 v[128:131], v16, s[32:35], s48 offen sc1
    s_endpgm
L_end:
    s_endpgm
.section .rodata,"a"
.p2align 6
.amdhsa_kernel standalone__batchnorm__prompt_kernel
  .amdhsa_next_free_vgpr 256
  .amdhsa_next_free_sgpr 102
  .amdhsa_accum_offset 256
  .amdhsa_group_segment_fixed_size 0
  .amdhsa_kernarg_size 72
  .amdhsa_user_sgpr_count 2
  .amdhsa_user_sgpr_kernarg_segment_ptr 1
  .amdhsa_system_sgpr_workgroup_id_x 1
.end_amdhsa_kernel
```
